```python
import torch

def _softmax(x, axis=-1):
    return torch.softmax(x, dim=axis)
def _gelu(x):
    return torch.nn.functional.gelu(x, approximate="tanh")
def _silu(x):
    return torch.nn.functional.silu(x)
def _sigmoid(x):
    return torch.sigmoid(x)
def _layernorm(x, axis=-1, eps=1e-5):
    m = x.mean(dim=axis, keepdim=True)
    v = x.var(dim=axis, keepdim=True, unbiased=False)
    return (x - m) / torch.sqrt(v + eps)
def _scatter_add(tgt, idx, src, axis=0):
    return tgt.clone().index_add_(axis, idx, src)
def _segment_sum(src, seg, n):
    out = torch.zeros((n,) + src.shape[1:], dtype=src.dtype)
    return out.index_add_(0, seg, src)
def _pad(x, pw):
    flat = tuple(v for pair in reversed(pw) for v in pair)
    return torch.nn.functional.pad(x, flat)

kernel_name = 'concat_heads__sliding_block_cached__mha_block_cached__decode'

def setup_inputs():

    _w = (lambda a: (lambda t: t.to(torch.bfloat16) if t.is_floating_point() else t)(torch.as_tensor(a)))
    def _A_setup():
        B, Sq, D = 8, 1, 512
        Hq, Hkv, Sk, Dh = 32, 8, 4096, 128
        assert Hq % Hkv == 0, (Hq, Hkv)
        return {
            "x": _w((lambda *s: torch.randn(*s, dtype=torch.bfloat16) * 0.8)(B, Sq, D)),
            "k_cache": _w((lambda *s: torch.randn(*s, dtype=torch.bfloat16) * 1.6)(B, Hkv, Sk, Dh)),
            "v_cache": _w((lambda *s: torch.randn(*s, dtype=torch.bfloat16) * 0.2)(B, Hkv, Sk, Dh)),
            "wq": _w((lambda *s: torch.randn(*s, dtype=torch.bfloat16) * 1.6)(D, Hq * Dh) * (D ** -0.5)),
            "wo": _w((lambda *s: torch.randn(*s, dtype=torch.bfloat16) * 0.2)(Hq * Dh, D) * ((Hq * Dh) ** -0.5)),
        }
    _A_in = _A_setup()

    def _B_setup():
        B, Sq, D = 8, 1, 512
        H, Sk, Dh = 32, 4096, 128
        return {
            "x": _w((lambda *s: torch.randn(*s, dtype=torch.bfloat16) * 0.8)(B, Sq, D)),
            "k_cache": _w((lambda *s: torch.randn(*s, dtype=torch.bfloat16) * 1.6)(B, H, Sk, Dh)),
            "v_cache": _w((lambda *s: torch.randn(*s, dtype=torch.bfloat16) * 0.2)(B, H, Sk, Dh)),
            "wq": _w((lambda *s: torch.randn(*s, dtype=torch.bfloat16) * 1.6)(D, H * Dh) * (D ** -0.5)),
            "wo": _w((lambda *s: torch.randn(*s, dtype=torch.bfloat16) * 0.2)(H * Dh, D) * ((H * Dh) ** -0.5)),
        }
    _B_in = _B_setup()

    return {
        "A_x": _A_in["x"],
        "A_k_cache": _A_in["k_cache"],
        "A_v_cache": _A_in["v_cache"],
        "A_wq": _A_in["wq"],
        "A_wo": _A_in["wo"],
        "B_x": _B_in["x"],
        "B_k_cache": _B_in["k_cache"],
        "B_v_cache": _B_in["v_cache"],
        "B_wq": _B_in["wq"],
        "B_wo": _B_in["wo"],
    }

def reference(A_x, A_k_cache, A_v_cache, A_wq, A_wo, B_x, B_k_cache, B_v_cache, B_wq, B_wo):
    def _A_ref(x, k_cache, v_cache, wq, wo):
        B, Sq, D = x.shape
        Hq, Dh = 32, 128
        Hkv, Sk = k_cache.shape[1], k_cache.shape[2]
        W = min(4096, max(256, Sk // 4))
        rep = Hq // Hkv
        q = (lambda x, *d: x.permute(*d))((x @ wq).reshape(B, Sq, Hq, Dh), 0, 2, 1, 3)
        k = (lambda x, n, axis: torch.repeat_interleave(x, n, dim=axis))(k_cache[:, :, Sk - W:, :], rep, axis=1)
        v = (lambda x, n, axis: torch.repeat_interleave(x, n, dim=axis))(v_cache[:, :, Sk - W:, :], rep, axis=1)
        scores = torch.einsum("bhqd,bhkd->bhqk", q, k) * (Dh ** -0.5)
        p = _softmax(scores, axis=-1)
        o = torch.einsum("bhqk,bhkd->bhqd", p, v)
        return (lambda x, *d: x.permute(*d))(o, 0, 2, 1, 3).reshape(B, Sq, Hq * Dh) @ wo

    def _B_ref(x, k_cache, v_cache, wq, wo):
        B, Sq, D = x.shape
        H, Dh = 32, 128
        q = (lambda x, *d: x.permute(*d))((x @ wq).reshape(B, Sq, H, Dh), 0, 2, 1, 3)
        scores = torch.einsum("bhqd,bhkd->bhqk", q, k_cache) * (Dh ** -0.5)
        p = _softmax(scores, axis=-1)
        o = torch.einsum("bhqk,bhkd->bhqd", p, v_cache)
        return (lambda x, *d: x.permute(*d))(o, 0, 2, 1, 3).reshape(B, Sq, H * Dh) @ wo

    a = _A_ref(A_x, A_k_cache, A_v_cache, A_wq, A_wo)
    b = _B_ref(B_x, B_k_cache, B_v_cache, B_wq, B_wo)
    return torch.concatenate([a, b], axis=-1)
```

```asm
; @launch grid=(256,1,1) block=(512,1,1) lds=74752
.amdgcn_target "amdgcn-amd-amdhsa--gfx950"
.text
.globl concat_heads__sliding_block_cached__mha_block_cached__decode_kernel
.p2align 8
.type concat_heads__sliding_block_cached__mha_block_cached__decode_kernel,@function
concat_heads__sliding_block_cached__mha_block_cached__decode_kernel:
    s_cmp_ge_u32 s2, 256
    s_cbranch_scc1 L_end
    s_load_dwordx16 s[36:51], s[0:1], 0
    s_load_dwordx8 s[52:59], s[0:1], 64
    s_load_dwordx2 s[60:61], s[0:1], 96
    v_lshrrev_b32 v1, 6, v0
    v_and_b32 v0, 63, v0
    s_and_b32 s62, s2, 7
    v_readfirstlane_b32 s3, v1
    s_lshr_b32 s63, s2, 3
    s_and_b32 s65, s62, 3
    s_mov_b32 s11, 0x20000
    s_mov_b32 s15, s11
    s_cmp_ge_u32 s3, 4
    s_cbranch_scc1 L_helper
    v_lshrrev_b32 v3, 4, v0
    v_bfe_u32 v4, v0, 2, 2
    v_and_b32 v5, 3, v0
    v_lshlrev_b32 v1, 8, v4
    v_lshl_add_u32 v1, v3, 6, v1
    v_lshl_add_u32 v1, v5, 4, v1
    s_lshl_b32 s81, s3, 12
    s_lshl_b32 s4, s62, 5
    s_add_u32 s4, s4, s63
    s_lshl_b32 s70, s4, 20
    s_mov_b32 s74, s81
    s_bitcmp1_b32 s2, 3
    s_cselect_b32 s4, 0x40000, 0
    s_xor_b32 s74, s74, s4
    s_bitcmp1_b32 s2, 6
    s_cselect_b32 s4, 0x80000, 0
    s_xor_b32 s74, s74, s4
    s_bitcmp1_b32 s2, 2
    s_cselect_b32 s4, 0x40000, 0
    s_xor_b32 s74, s74, s4
    s_bitcmp1_b32 s2, 1
    s_cselect_b32 s4, 0x4000, 0
    s_xor_b32 s74, s74, s4
    s_mov_b32 s10, 0x10000000
    s_waitcnt lgkmcnt(0)
    s_mov_b32 s8, s48
    s_and_b32 s9, s49, 0xffff
    s_xor_b32 s73, s70, s74
    buffer_load_dwordx4 v[64:67], v1, s[8:11], s73 offen offset:0 nt
    buffer_load_dwordx4 v[68:71], v1, s[8:11], s73 offen offset:1024 nt
    buffer_load_dwordx4 v[72:75], v1, s[8:11], s73 offen offset:2048 nt
    buffer_load_dwordx4 v[76:79], v1, s[8:11], s73 offen offset:3072 nt
    s_add_u32 s70, s70, 0x4000
    s_xor_b32 s73, s70, s74
    s_waitcnt vmcnt(4)
    buffer_load_dwordx4 v[80:83], v1, s[8:11], s73 offen offset:0 nt
    s_bfe_u32 s67, s63, 0x10003
    s_lshr_b32 s4, s62, 2
    s_lshl1_add_u32 s67, s4, s67
    s_lshr_b32 s4, s63, 4
    s_lshl2_add_u32 s67, s4, s67
    s_and_b32 s68, s63, 4
    s_or_b32 s68, s68, s65
    s_and_b32 s69, s63, 3
    s_mov_b32 s77, 0x3e0293ee
    s_mov_b32 s82, 0x400000
    s_mov_b32 s24, s60
    s_and_b32 s25, s61, 0xffff
    s_mov_b32 s26, 0xa00000
    s_mov_b32 s27, 0x20000
    s_mov_b32 s12, s50
    s_and_b32 s13, s51, 0xffff
    s_mov_b32 s14, 0x10000000
    s_mov_b32 s15, 0x20000
    s_mov_b32 s16, s38
    s_and_b32 s17, s39, 0xffff
    s_mov_b32 s18, 0x4000000
    s_mov_b32 s19, 0x20000
    s_mov_b32 s20, s40
    s_and_b32 s21, s41, 0xffff
    s_mov_b32 s22, 0x4000000
    s_mov_b32 s23, 0x20000
    v_lshlrev_b32 v2, 4, v0
    s_lshl3_add_u32 s4, s67, s68
    s_lshl_b32 s4, s4, 20
    s_lshl_b32 s5, s69, 16
    s_add_u32 s79, s4, s5
    s_add_u32 s79, s79, s81
    s_add_u32 s79, s79, 0xc0000
    s_bitcmp1_b32 s2, 3
    s_cselect_b32 s4, 0x4000, 0
    s_xor_b32 s79, s79, s4
    s_barrier
    s_waitcnt vmcnt(4)
    buffer_load_dwordx4 v[84:87], v1, s[8:11], s73 offen offset:1024 nt
    s_waitcnt vmcnt(4)
    buffer_load_dwordx4 v[88:91], v1, s[8:11], s73 offen offset:2048 nt
    s_waitcnt vmcnt(4)
    buffer_load_dwordx4 v[92:95], v1, s[8:11], s73 offen offset:3072 nt
    s_add_u32 s70, s70, 0x4000
    s_xor_b32 s73, s70, s74
    s_waitcnt vmcnt(4)
    buffer_load_dwordx4 v[96:99], v1, s[8:11], s73 offen offset:0 nt
    s_waitcnt vmcnt(4)
    buffer_load_dwordx4 v[100:103], v1, s[8:11], s73 offen offset:1024 nt
    s_waitcnt vmcnt(4)
    buffer_load_dwordx4 v[104:107], v1, s[8:11], s73 offen offset:2048 nt
    s_waitcnt vmcnt(4)
    buffer_load_dwordx4 v[108:111], v1, s[8:11], s73 offen offset:3072 nt
    s_add_u32 s70, s70, 0x4000
    s_xor_b32 s73, s70, s74
    s_waitcnt vmcnt(4)
    buffer_load_dwordx4 v[112:115], v1, s[8:11], s73 offen offset:0 nt
    s_waitcnt vmcnt(4)
    buffer_load_dwordx4 v[116:119], v1, s[8:11], s73 offen offset:1024 nt
    s_waitcnt vmcnt(4)
    buffer_load_dwordx4 v[120:123], v1, s[8:11], s73 offen offset:2048 nt
    s_waitcnt vmcnt(4)
    buffer_load_dwordx4 v[124:127], v1, s[8:11], s73 offen offset:3072 nt
    s_add_u32 s70, s70, 0x4000
    s_xor_b32 s73, s79, 0
    s_waitcnt vmcnt(4)
    buffer_load_dwordx4 v[128:131], v1, s[16:19], s73 offen offset:0 nt
    s_waitcnt vmcnt(4)
    buffer_load_dwordx4 v[132:135], v1, s[16:19], s73 offen offset:1024 nt
    s_waitcnt vmcnt(4)
    buffer_load_dwordx4 v[136:139], v1, s[16:19], s73 offen offset:2048 nt
    s_waitcnt vmcnt(4)
    buffer_load_dwordx4 v[140:143], v1, s[16:19], s73 offen offset:3072 nt
    s_xor_b32 s73, s79, 16384
    s_waitcnt vmcnt(4)
    buffer_load_dwordx4 v[160:163], v1, s[16:19], s73 offen offset:0 nt
    s_waitcnt vmcnt(4)
    buffer_load_dwordx4 v[164:167], v1, s[16:19], s73 offen offset:1024 nt
    s_waitcnt vmcnt(4)
    buffer_load_dwordx4 v[168:171], v1, s[16:19], s73 offen offset:2048 nt
    s_waitcnt vmcnt(4)
    buffer_load_dwordx4 v[172:175], v1, s[16:19], s73 offen offset:3072 nt
    s_xor_b32 s73, s79, 32768
    s_waitcnt vmcnt(4)
    buffer_load_dwordx4 v[192:195], v1, s[16:19], s73 offen offset:0 nt
    s_waitcnt vmcnt(4)
    buffer_load_dwordx4 v[196:199], v1, s[16:19], s73 offen offset:1024 nt
    s_waitcnt vmcnt(4)
    buffer_load_dwordx4 v[200:203], v1, s[16:19], s73 offen offset:2048 nt
    s_waitcnt vmcnt(4)
    buffer_load_dwordx4 v[204:207], v1, s[16:19], s73 offen offset:3072 nt
    s_xor_b32 s73, s79, 49152
    s_waitcnt vmcnt(4)
    buffer_load_dwordx4 v[224:227], v1, s[16:19], s73 offen offset:0 nt
    s_waitcnt vmcnt(4)
    buffer_load_dwordx4 v[228:231], v1, s[16:19], s73 offen offset:1024 nt
    s_waitcnt vmcnt(4)
    buffer_load_dwordx4 v[232:235], v1, s[16:19], s73 offen offset:2048 nt
    s_waitcnt vmcnt(4)
    buffer_load_dwordx4 v[236:239], v1, s[16:19], s73 offen offset:3072 nt
    s_xor_b32 s73, s79, 0
    s_waitcnt vmcnt(4)
    buffer_load_dwordx4 v[144:147], v2, s[20:23], s73 offen offset:0 nt
    s_waitcnt vmcnt(4)
    buffer_load_dwordx4 v[148:151], v2, s[20:23], s73 offen offset:1024 nt
    s_waitcnt vmcnt(4)
    buffer_load_dwordx4 v[152:155], v2, s[20:23], s73 offen offset:2048 nt
    s_waitcnt vmcnt(4)
    buffer_load_dwordx4 v[156:159], v2, s[20:23], s73 offen offset:3072 nt
    s_xor_b32 s73, s79, 16384
    s_waitcnt vmcnt(4)
    buffer_load_dwordx4 v[176:179], v2, s[20:23], s73 offen offset:0 nt
    s_waitcnt vmcnt(4)
    buffer_load_dwordx4 v[180:183], v2, s[20:23], s73 offen offset:1024 nt
    s_waitcnt vmcnt(4)
    buffer_load_dwordx4 v[184:187], v2, s[20:23], s73 offen offset:2048 nt
    s_waitcnt vmcnt(4)
    buffer_load_dwordx4 v[188:191], v2, s[20:23], s73 offen offset:3072 nt
    s_xor_b32 s73, s79, 32768
    s_waitcnt vmcnt(4)
    buffer_load_dwordx4 v[208:211], v2, s[20:23], s73 offen offset:0 nt
    s_waitcnt vmcnt(4)
    buffer_load_dwordx4 v[212:215], v2, s[20:23], s73 offen offset:1024 nt
    s_waitcnt vmcnt(4)
    buffer_load_dwordx4 v[216:219], v2, s[20:23], s73 offen offset:2048 nt
    s_waitcnt vmcnt(4)
    buffer_load_dwordx4 v[220:223], v2, s[20:23], s73 offen offset:3072 nt
    s_xor_b32 s73, s79, 49152
    buffer_load_dwordx4 v[240:243], v2, s[20:23], s73 offen offset:0 nt
    buffer_load_dwordx4 v[244:247], v2, s[20:23], s73 offen offset:1024 nt
    buffer_load_dwordx4 v[248:251], v2, s[20:23], s73 offen offset:2048 nt
    buffer_load_dwordx4 v[252:255], v2, s[20:23], s73 offen offset:3072 nt
    v_lshlrev_b32 v6, 6, v5
    v_lshl_add_u32 v6, v3, 4, v6
    v_lshl_add_u32 v6, v4, 2, v6
    s_add_u32 s4, s81, 16384
    v_add_u32 v6, s4, v6
    v_mov_b32 v3, v4
    v_and_b32 v8, 1, v5
    v_lshlrev_b32 v8, 4, v8
    v_mov_b32 v7, 0xffff
    v_lshlrev_b32 v8, v8, v7
    v_cmp_le_u32 vcc, 2, v5
    s_nop 1
    v_cndmask_b32 v5, 0, v8, vcc
    v_xor_b32 v4, v5, v8
    v_mov_b32 v12, 0
    v_mov_b32 v13, 0
    v_mov_b32 v14, 0
    v_mov_b32 v15, 0
    v_mov_b32 v32, 0
    v_mov_b32 v33, 0
    v_mov_b32 v34, 0
    v_mov_b32 v35, 0
    v_mov_b32 v36, 0
    v_mov_b32 v37, 0
    v_mov_b32 v38, 0
    v_mov_b32 v39, 0
    v_mov_b32 v7, 0
    v_mov_b32 v9, 0
    v_mov_b32 v10, 0xff7fffff
    v_mov_b32 v11, v10
    v_mul_f32 v8, s77, v10
    s_mov_b32 s28, 0x11111111
    s_mov_b32 s29, s28
    s_mov_b32 s30, 0x22222222
    s_mov_b32 s31, s30
    s_mov_b32 s32, 0x44444444
    s_mov_b32 s33, s32
    s_mov_b32 s34, 0x88888888
    s_mov_b32 s35, s34
    s_mov_b32 s71, 4
    s_mov_b32 s76, 0
    s_mov_b32 s79, 0
    s_mov_b32 s36, 0
    s_mov_b32 s37, 0x1000
    v_mov_b32 v60, 0
L_sp_1:
    ds_read_b32 v61, v60
    s_waitcnt lgkmcnt(0)
    v_readfirstlane_b32 s4, v61
    s_nop 0
    s_cmp_lg_u32 s4, 0
    s_cbranch_scc1 L_ok_2
    s_sleep 1
    s_sub_u32 s82, s82, 1
    s_cmp_lg_u32 s82, 0
    s_cbranch_scc1 L_sp_1
    s_endpgm
L_ok_2:
    v_and_b32 v60, 0xff, v1
    ds_read_b128 v[40:43], v60 offset:1024
    s_waitcnt lgkmcnt(0)
    v_cmp_eq_u32 vcc, 0, v3
    s_nop 1
    v_cndmask_b32 v16, 0, v40, vcc
    v_cndmask_b32 v17, 0, v41, vcc
    v_cndmask_b32 v18, 0, v42, vcc
    v_cndmask_b32 v19, 0, v43, vcc
    v_cmp_eq_u32 vcc, 1, v3
    s_nop 1
    v_cndmask_b32 v20, 0, v40, vcc
    v_cndmask_b32 v21, 0, v41, vcc
    v_cndmask_b32 v22, 0, v42, vcc
    v_cndmask_b32 v23, 0, v43, vcc
    v_cmp_eq_u32 vcc, 2, v3
    s_nop 1
    v_cndmask_b32 v24, 0, v40, vcc
    v_cndmask_b32 v25, 0, v41, vcc
    v_cndmask_b32 v26, 0, v42, vcc
    v_cndmask_b32 v27, 0, v43, vcc
    v_cmp_eq_u32 vcc, 3, v3
    s_nop 1
    v_cndmask_b32 v28, 0, v40, vcc
    v_cndmask_b32 v29, 0, v41, vcc
    v_cndmask_b32 v30, 0, v42, vcc
    v_cndmask_b32 v31, 0, v43, vcc
    v_mov_b32 v3, 1
L_k:
    s_waitcnt vmcnt(12)
    v_mfma_f32_16x16x32_bf16 v[40:43], v[64:67], v[16:19], 0
    v_mfma_f32_16x16x32_bf16 v[40:43], v[68:71], v[20:23], v[40:43]
    v_mfma_f32_16x16x32_bf16 v[40:43], v[72:75], v[24:27], v[40:43]
    v_mfma_f32_16x16x32_bf16 v[40:43], v[76:79], v[28:31], v[40:43]
    s_xor_b32 s73, s70, s74
    s_cmp_gt_i32 s76, 60
    s_cselect_b32 s5, 0x1000, s36
    s_add_u32 s4, s76, 40
    s_cmp_lt_i32 s4, s5
    s_cselect_b64 vcc, -1, 0
    s_max_i32 s4, s76, s5
    s_cmp_gt_i32 s4, 10
    s_cbranch_scc1 L_wa_3
    s_waitcnt vmcnt(4)
    s_cbranch_vccz L_go_4
    s_waitcnt vmcnt(3)
L_wa_3:
    s_cbranch_vccnz L_go_4
    s_waitcnt vmcnt(5)
L_go_4:
    buffer_load_dwordx4 v[64:67], v1, s[8:11], s73 offen offset:0 nt
    s_mov_b64 exec, 1
    ds_add_u32 v2, v3 offset:4
    ds_read_b64 v[58:59], v2 offset:96
    s_mov_b64 exec, -1
    s_memrealtime s[6:7]
    s_cbranch_scc1 L_wa_5
    s_waitcnt vmcnt(4)
    s_cbranch_vccz L_go_6
    s_waitcnt vmcnt(3)
L_wa_5:
    s_cbranch_vccnz L_go_6
    s_waitcnt vmcnt(5)
L_go_6:
    buffer_load_dwordx4 v[68:71], v1, s[8:11], s73 offen offset:1024 nt
    s_cbranch_scc1 L_wa_7
    s_waitcnt vmcnt(4)
    s_cbranch_vccz L_go_8
    s_waitcnt vmcnt(3)
L_wa_7:
    s_cbranch_vccnz L_go_8
    s_waitcnt vmcnt(5)
L_go_8:
    buffer_load_dwordx4 v[72:75], v1, s[8:11], s73 offen offset:2048 nt
    s_waitcnt lgkmcnt(0)
    v_readfirstlane_b32 s76, v58
    v_readfirstlane_b32 s75, v59
    s_cbranch_scc1 L_wa_9
    s_waitcnt vmcnt(4)
    s_cbranch_vccz L_go_10
    s_waitcnt vmcnt(3)
L_wa_9:
    s_cbranch_vccnz L_go_10
    s_waitcnt vmcnt(5)
L_go_10:
    buffer_load_dwordx4 v[76:79], v1, s[8:11], s73 offen offset:3072 nt
    s_add_u32 s70, s70, 0x4000
    s_add_u32 s71, s71, 1
    s_mul_i32 s4, s75, s71
    s_lshr_b32 s4, s4, 8
    s_add_u32 s76, s76, s4
    s_sub_u32 s76, s6, s76
    s_min_i32 s76, s76, 0x400
    s_cmp_eq_u32 s75, 0
    s_cselect_b32 s76, 0, s76
    v_mov_b32_dpp v56, v40 quad_perm:[0,0,0,0] row_mask:0xf bank_mask:0xf
    v_mov_b32_dpp v57, v41 quad_perm:[1,1,1,1] row_mask:0xf bank_mask:0xf
    s_nop 0
    v_add_f32_dpp v56, v42, v56 quad_perm:[2,2,2,2] row_mask:0xf bank_mask:0xf
    v_add_f32_dpp v57, v43, v57 quad_perm:[3,3,3,3] row_mask:0xf bank_mask:0xf
    v_add_f32 v56, v56, v57
    v_cndmask_b32 v7, v7, v56, s[28:29]
    s_waitcnt vmcnt(12)
    v_mfma_f32_16x16x32_bf16 v[40:43], v[80:83], v[16:19], 0
    v_mfma_f32_16x16x32_bf16 v[40:43], v[84:87], v[20:23], v[40:43]
    v_mfma_f32_16x16x32_bf16 v[40:43], v[88:91], v[24:27], v[40:43]
    v_mfma_f32_16x16x32_bf16 v[40:43], v[92:95], v[28:31], v[40:43]
    s_xor_b32 s73, s70, s74
    s_cmp_gt_i32 s76, 60
    s_cselect_b32 s5, 0x1000, s36
    s_add_u32 s4, s76, 40
    s_cmp_lt_i32 s4, s5
    s_cselect_b64 vcc, -1, 0
    s_max_i32 s4, s76, s5
    s_cmp_gt_i32 s4, 10
    s_cbranch_scc1 L_wa_11
    s_waitcnt vmcnt(4)
    s_cbranch_vccz L_go_12
    s_waitcnt vmcnt(3)
L_wa_11:
    s_cbranch_vccnz L_go_12
    s_waitcnt vmcnt(5)
L_go_12:
    buffer_load_dwordx4 v[80:83], v1, s[8:11], s73 offen offset:0 nt
    s_mov_b64 exec, 1
    ds_add_u32 v2, v3 offset:4
    ds_read_b64 v[58:59], v2 offset:96
    s_mov_b64 exec, -1
    s_memrealtime s[6:7]
    s_cbranch_scc1 L_wa_13
    s_waitcnt vmcnt(4)
    s_cbranch_vccz L_go_14
    s_waitcnt vmcnt(3)
L_wa_13:
    s_cbranch_vccnz L_go_14
    s_waitcnt vmcnt(5)
L_go_14:
    buffer_load_dwordx4 v[84:87], v1, s[8:11], s73 offen offset:1024 nt
    s_cbranch_scc1 L_wa_15
    s_waitcnt vmcnt(4)
    s_cbranch_vccz L_go_16
    s_waitcnt vmcnt(3)
L_wa_15:
    s_cbranch_vccnz L_go_16
    s_waitcnt vmcnt(5)
L_go_16:
    buffer_load_dwordx4 v[88:91], v1, s[8:11], s73 offen offset:2048 nt
    s_waitcnt lgkmcnt(0)
    v_readfirstlane_b32 s76, v58
    v_readfirstlane_b32 s75, v59
    s_cbranch_scc1 L_wa_17
    s_waitcnt vmcnt(4)
    s_cbranch_vccz L_go_18
    s_waitcnt vmcnt(3)
L_wa_17:
    s_cbranch_vccnz L_go_18
    s_waitcnt vmcnt(5)
L_go_18:
    buffer_load_dwordx4 v[92:95], v1, s[8:11], s73 offen offset:3072 nt
    s_add_u32 s70, s70, 0x4000
    s_add_u32 s71, s71, 1
    s_mul_i32 s4, s75, s71
    s_lshr_b32 s4, s4, 8
    s_add_u32 s76, s76, s4
    s_sub_u32 s76, s6, s76
    s_min_i32 s76, s76, 0x400
    s_cmp_eq_u32 s75, 0
    s_cselect_b32 s76, 0, s76
    v_mov_b32_dpp v56, v40 quad_perm:[0,0,0,0] row_mask:0xf bank_mask:0xf
    v_mov_b32_dpp v57, v41 quad_perm:[1,1,1,1] row_mask:0xf bank_mask:0xf
    s_nop 0
    v_add_f32_dpp v56, v42, v56 quad_perm:[2,2,2,2] row_mask:0xf bank_mask:0xf
    v_add_f32_dpp v57, v43, v57 quad_perm:[3,3,3,3] row_mask:0xf bank_mask:0xf
    v_add_f32 v56, v56, v57
    v_cndmask_b32 v7, v7, v56, s[30:31]
    s_waitcnt vmcnt(12)
    v_mfma_f32_16x16x32_bf16 v[40:43], v[96:99], v[16:19], 0
    v_mfma_f32_16x16x32_bf16 v[40:43], v[100:103], v[20:23], v[40:43]
    v_mfma_f32_16x16x32_bf16 v[40:43], v[104:107], v[24:27], v[40:43]
    v_mfma_f32_16x16x32_bf16 v[40:43], v[108:111], v[28:31], v[40:43]
    s_xor_b32 s73, s70, s74
    s_cmp_gt_i32 s76, 60
    s_cselect_b32 s5, 0x1000, s36
    s_add_u32 s4, s76, 40
    s_cmp_lt_i32 s4, s5
    s_cselect_b64 vcc, -1, 0
    s_max_i32 s4, s76, s5
    s_cmp_gt_i32 s4, 10
    s_cbranch_scc1 L_wa_19
    s_waitcnt vmcnt(4)
    s_cbranch_vccz L_go_20
    s_waitcnt vmcnt(3)
L_wa_19:
    s_cbranch_vccnz L_go_20
    s_waitcnt vmcnt(5)
L_go_20:
    buffer_load_dwordx4 v[96:99], v1, s[8:11], s73 offen offset:0 nt
    s_mov_b64 exec, 1
    ds_add_u32 v2, v3 offset:4
    ds_read_b64 v[58:59], v2 offset:96
    s_mov_b64 exec, -1
    s_memrealtime s[6:7]
    s_cbranch_scc1 L_wa_21
    s_waitcnt vmcnt(4)
    s_cbranch_vccz L_go_22
    s_waitcnt vmcnt(3)
L_wa_21:
    s_cbranch_vccnz L_go_22
    s_waitcnt vmcnt(5)
L_go_22:
    buffer_load_dwordx4 v[100:103], v1, s[8:11], s73 offen offset:1024 nt
    s_cbranch_scc1 L_wa_23
    s_waitcnt vmcnt(4)
    s_cbranch_vccz L_go_24
    s_waitcnt vmcnt(3)
L_wa_23:
    s_cbranch_vccnz L_go_24
    s_waitcnt vmcnt(5)
L_go_24:
    buffer_load_dwordx4 v[104:107], v1, s[8:11], s73 offen offset:2048 nt
    s_waitcnt lgkmcnt(0)
    v_readfirstlane_b32 s76, v58
    v_readfirstlane_b32 s75, v59
    s_cbranch_scc1 L_wa_25
    s_waitcnt vmcnt(4)
    s_cbranch_vccz L_go_26
    s_waitcnt vmcnt(3)
L_wa_25:
    s_cbranch_vccnz L_go_26
    s_waitcnt vmcnt(5)
L_go_26:
    buffer_load_dwordx4 v[108:111], v1, s[8:11], s73 offen offset:3072 nt
    s_add_u32 s70, s70, 0x4000
    s_add_u32 s71, s71, 1
    s_mul_i32 s4, s75, s71
    s_lshr_b32 s4, s4, 8
    s_add_u32 s76, s76, s4
    s_sub_u32 s76, s6, s76
    s_min_i32 s76, s76, 0x400
    s_cmp_eq_u32 s75, 0
    s_cselect_b32 s76, 0, s76
    v_mov_b32_dpp v56, v40 quad_perm:[0,0,0,0] row_mask:0xf bank_mask:0xf
    v_mov_b32_dpp v57, v41 quad_perm:[1,1,1,1] row_mask:0xf bank_mask:0xf
    s_nop 0
    v_add_f32_dpp v56, v42, v56 quad_perm:[2,2,2,2] row_mask:0xf bank_mask:0xf
    v_add_f32_dpp v57, v43, v57 quad_perm:[3,3,3,3] row_mask:0xf bank_mask:0xf
    v_add_f32 v56, v56, v57
    v_cndmask_b32 v7, v7, v56, s[32:33]
    s_waitcnt vmcnt(12)
    v_mfma_f32_16x16x32_bf16 v[40:43], v[112:115], v[16:19], 0
    v_mfma_f32_16x16x32_bf16 v[40:43], v[116:119], v[20:23], v[40:43]
    v_mfma_f32_16x16x32_bf16 v[40:43], v[120:123], v[24:27], v[40:43]
    v_mfma_f32_16x16x32_bf16 v[40:43], v[124:127], v[28:31], v[40:43]
    s_xor_b32 s73, s70, s74
    s_cmp_gt_i32 s76, 60
    s_cselect_b32 s5, 0x1000, s37
    s_add_u32 s4, s76, 40
    s_cmp_lt_i32 s4, s5
    s_cselect_b64 vcc, -1, 0
    s_max_i32 s4, s76, s5
    s_cmp_gt_i32 s4, 10
    s_cbranch_scc1 L_wa_27
    s_waitcnt vmcnt(4)
    s_cbranch_vccz L_go_28
    s_waitcnt vmcnt(3)
L_wa_27:
    s_cbranch_vccnz L_go_28
    s_waitcnt vmcnt(5)
L_go_28:
    buffer_load_dwordx4 v[112:115], v1, s[8:11], s73 offen offset:0 nt
    s_mov_b64 exec, 1
    ds_add_u32 v2, v3 offset:4
    ds_read_b64 v[58:59], v2 offset:96
    s_mov_b64 exec, -1
    s_memrealtime s[6:7]
    s_cbranch_scc1 L_wa_29
    s_waitcnt vmcnt(4)
    s_cbranch_vccz L_go_30
    s_waitcnt vmcnt(3)
L_wa_29:
    s_cbranch_vccnz L_go_30
    s_waitcnt vmcnt(5)
L_go_30:
    buffer_load_dwordx4 v[116:119], v1, s[8:11], s73 offen offset:1024 nt
    s_cbranch_scc1 L_wa_31
    s_waitcnt vmcnt(4)
    s_cbranch_vccz L_go_32
    s_waitcnt vmcnt(3)
L_wa_31:
    s_cbranch_vccnz L_go_32
    s_waitcnt vmcnt(5)
L_go_32:
    buffer_load_dwordx4 v[120:123], v1, s[8:11], s73 offen offset:2048 nt
    s_waitcnt lgkmcnt(0)
    v_readfirstlane_b32 s76, v58
    v_readfirstlane_b32 s75, v59
    s_cbranch_scc1 L_wa_33
    s_waitcnt vmcnt(4)
    s_cbranch_vccz L_go_34
    s_waitcnt vmcnt(3)
L_wa_33:
    s_cbranch_vccnz L_go_34
    s_waitcnt vmcnt(5)
L_go_34:
    buffer_load_dwordx4 v[124:127], v1, s[8:11], s73 offen offset:3072 nt
    s_add_u32 s70, s70, 0x4000
    s_add_u32 s71, s71, 1
    s_mul_i32 s4, s75, s71
    s_lshr_b32 s4, s4, 8
    s_add_u32 s76, s76, s4
    s_sub_u32 s76, s6, s76
    s_min_i32 s76, s76, 0x400
    s_cmp_eq_u32 s75, 0
    s_cselect_b32 s76, 0, s76
    v_mov_b32_dpp v56, v40 quad_perm:[0,0,0,0] row_mask:0xf bank_mask:0xf
    v_mov_b32_dpp v57, v41 quad_perm:[1,1,1,1] row_mask:0xf bank_mask:0xf
    s_nop 0
    v_add_f32_dpp v56, v42, v56 quad_perm:[2,2,2,2] row_mask:0xf bank_mask:0xf
    v_add_f32_dpp v57, v43, v57 quad_perm:[3,3,3,3] row_mask:0xf bank_mask:0xf
    v_add_f32 v56, v56, v57
    v_cndmask_b32 v7, v7, v56, s[34:35]
    ds_write_b32 v6, v7
    v_max_f32 v11, v11, v7
    v_add_u32 v6, 0x100, v6
    s_cmp_ge_u32 s71, 64
    s_cbranch_scc1 L_kend
    s_cmp_ge_u32 s79, 4
    s_cbranch_scc1 L_k
    s_cmp_eq_u32 s79, 1
    s_cbranch_scc1 L_a1
    s_cmp_eq_u32 s79, 2
    s_cbranch_scc1 L_a2
    s_cmp_eq_u32 s79, 3
    s_cbranch_scc1 L_a3
    v_mov_b32 v60, 24
L_a_spin:
    ds_read_b32 v61, v60
    ds_read_b128 v[12:15], v1 offset:1280
    s_waitcnt lgkmcnt(0)
    v_readfirstlane_b32 s4, v61
    s_nop 0
    s_cmp_lg_u32 s4, 0
    s_cbranch_scc1 L_a0
    s_cmp_lt_u32 s71, 28
    s_cbranch_scc1 L_k
    s_sub_u32 s82, s82, 1
    s_cmp_lg_u32 s82, 0
    s_cbranch_scc1 L_a_spin
    s_endpgm
L_a0:
    s_waitcnt vmcnt(16)
    v_mfma_f32_16x16x32_bf16 v[40:43], v[128:131], v[12:15], 0
    v_mfma_f32_16x16x32_bf16 v[44:47], v[132:135], v[12:15], 0
    v_mfma_f32_16x16x32_bf16 v[48:51], v[136:139], v[12:15], 0
    v_mfma_f32_16x16x32_bf16 v[52:55], v[140:143], v[12:15], 0
    s_nop 5
    v_mov_b32_dpp v56, v40 quad_perm:[0,0,0,0] row_mask:0xf bank_mask:0xf
    v_mov_b32_dpp v57, v44 quad_perm:[0,0,0,0] row_mask:0xf bank_mask:0xf
    v_mov_b32_dpp v58, v48 quad_perm:[0,0,0,0] row_mask:0xf bank_mask:0xf
    v_mov_b32_dpp v59, v52 quad_perm:[0,0,0,0] row_mask:0xf bank_mask:0xf
    v_add_f32_dpp v56, v41, v56 quad_perm:[1,1,1,1] row_mask:0xf bank_mask:0xf
    v_add_f32_dpp v57, v45, v57 quad_perm:[1,1,1,1] row_mask:0xf bank_mask:0xf
    v_add_f32_dpp v58, v49, v58 quad_perm:[1,1,1,1] row_mask:0xf bank_mask:0xf
    v_add_f32_dpp v59, v53, v59 quad_perm:[1,1,1,1] row_mask:0xf bank_mask:0xf
    v_add_f32_dpp v56, v42, v56 quad_perm:[2,2,2,2] row_mask:0xf bank_mask:0xf
    v_add_f32_dpp v57, v46, v57 quad_perm:[2,2,2,2] row_mask:0xf bank_mask:0xf
    v_add_f32_dpp v58, v50, v58 quad_perm:[2,2,2,2] row_mask:0xf bank_mask:0xf
    v_add_f32_dpp v59, v54, v59 quad_perm:[2,2,2,2] row_mask:0xf bank_mask:0xf
    v_add_f32_dpp v56, v43, v56 quad_perm:[3,3,3,3] row_mask:0xf bank_mask:0xf
    v_add_f32_dpp v57, v47, v57 quad_perm:[3,3,3,3] row_mask:0xf bank_mask:0xf
    v_add_f32_dpp v58, v51, v58 quad_perm:[3,3,3,3] row_mask:0xf bank_mask:0xf
    v_add_f32_dpp v59, v55, v59 quad_perm:[3,3,3,3] row_mask:0xf bank_mask:0xf
    v_max3_f32 v60, v56, v57, v58
    v_max_f32 v60, v60, v59
    v_cmp_gt_f32 vcc, v60, v10
    s_cbranch_vccnz L_rs_35
L_bk_36:
    v_fma_f32 v56, v56, s77, -v8
    v_fma_f32 v57, v57, s77, -v8
    v_fma_f32 v58, v58, s77, -v8
    v_fma_f32 v59, v59, s77, -v8
    v_exp_f32 v56, v56
    v_exp_f32 v57, v57
    v_exp_f32 v58, v58
    v_exp_f32 v59, v59
    v_add_f32 v60, v56, v57
    v_cvt_pk_bf16_f32 v56, v56, v56
    v_add_f32 v61, v58, v59
    v_cvt_pk_bf16_f32 v57, v57, v57
    v_cvt_pk_bf16_f32 v58, v58, v58
    v_cvt_pk_bf16_f32 v59, v59, v59
    v_and_b32 v40, v56, v4
    v_and_b32 v41, v56, v5
    v_and_b32 v42, v57, v4
    v_and_b32 v43, v57, v5
    v_and_b32 v44, v58, v4
    v_and_b32 v45, v58, v5
    v_and_b32 v46, v59, v4
    v_and_b32 v47, v59, v5
    v_add_f32 v9, v9, v60
    v_add_f32 v9, v9, v61
    v_mfma_f32_16x16x16_bf16 v[32:35], v[144:145], v[40:41], v[32:35]
    v_mfma_f32_16x16x16_bf16 v[36:39], v[146:147], v[40:41], v[36:39]
    v_mfma_f32_16x16x16_bf16 v[32:35], v[148:149], v[42:43], v[32:35]
    v_mfma_f32_16x16x16_bf16 v[36:39], v[150:151], v[42:43], v[36:39]
    v_mfma_f32_16x16x16_bf16 v[32:35], v[152:153], v[44:45], v[32:35]
    v_mfma_f32_16x16x16_bf16 v[36:39], v[154:155], v[44:45], v[36:39]
    v_mfma_f32_16x16x16_bf16 v[32:35], v[156:157], v[46:47], v[32:35]
    v_mfma_f32_16x16x16_bf16 v[36:39], v[158:159], v[46:47], v[36:39]
    s_mov_b32 s79, 1
    s_branch L_k
L_a1:
    v_mfma_f32_16x16x32_bf16 v[40:43], v[160:163], v[12:15], 0
    v_mfma_f32_16x16x32_bf16 v[44:47], v[164:167], v[12:15], 0
    v_mfma_f32_16x16x32_bf16 v[48:51], v[168:171], v[12:15], 0
    v_mfma_f32_16x16x32_bf16 v[52:55], v[172:175], v[12:15], 0
    s_nop 5
    v_mov_b32_dpp v56, v40 quad_perm:[0,0,0,0] row_mask:0xf bank_mask:0xf
    v_mov_b32_dpp v57, v44 quad_perm:[0,0,0,0] row_mask:0xf bank_mask:0xf
    v_mov_b32_dpp v58, v48 quad_perm:[0,0,0,0] row_mask:0xf bank_mask:0xf
    v_mov_b32_dpp v59, v52 quad_perm:[0,0,0,0] row_mask:0xf bank_mask:0xf
    v_add_f32_dpp v56, v41, v56 quad_perm:[1,1,1,1] row_mask:0xf bank_mask:0xf
    v_add_f32_dpp v57, v45, v57 quad_perm:[1,1,1,1] row_mask:0xf bank_mask:0xf
    v_add_f32_dpp v58, v49, v58 quad_perm:[1,1,1,1] row_mask:0xf bank_mask:0xf
    v_add_f32_dpp v59, v53, v59 quad_perm:[1,1,1,1] row_mask:0xf bank_mask:0xf
    v_add_f32_dpp v56, v42, v56 quad_perm:[2,2,2,2] row_mask:0xf bank_mask:0xf
    v_add_f32_dpp v57, v46, v57 quad_perm:[2,2,2,2] row_mask:0xf bank_mask:0xf
    v_add_f32_dpp v58, v50, v58 quad_perm:[2,2,2,2] row_mask:0xf bank_mask:0xf
    v_add_f32_dpp v59, v54, v59 quad_perm:[2,2,2,2] row_mask:0xf bank_mask:0xf
    v_add_f32_dpp v56, v43, v56 quad_perm:[3,3,3,3] row_mask:0xf bank_mask:0xf
    v_add_f32_dpp v57, v47, v57 quad_perm:[3,3,3,3] row_mask:0xf bank_mask:0xf
    v_add_f32_dpp v58, v51, v58 quad_perm:[3,3,3,3] row_mask:0xf bank_mask:0xf
    v_add_f32_dpp v59, v55, v59 quad_perm:[3,3,3,3] row_mask:0xf bank_mask:0xf
    v_max3_f32 v60, v56, v57, v58
    v_max_f32 v60, v60, v59
    v_cmp_gt_f32 vcc, v60, v10
    s_cbranch_vccnz L_rs_37
L_bk_38:
    v_fma_f32 v56, v56, s77, -v8
    v_fma_f32 v57, v57, s77, -v8
    v_fma_f32 v58, v58, s77, -v8
    v_fma_f32 v59, v59, s77, -v8
    v_exp_f32 v56, v56
    v_exp_f32 v57, v57
    v_exp_f32 v58, v58
    v_exp_f32 v59, v59
    v_add_f32 v60, v56, v57
    v_cvt_pk_bf16_f32 v56, v56, v56
    v_add_f32 v61, v58, v59
    v_cvt_pk_bf16_f32 v57, v57, v57
    v_cvt_pk_bf16_f32 v58, v58, v58
    v_cvt_pk_bf16_f32 v59, v59, v59
    v_and_b32 v40, v56, v4
    v_and_b32 v41, v56, v5
    v_and_b32 v42, v57, v4
    v_and_b32 v43, v57, v5
    v_and_b32 v44, v58, v4
    v_and_b32 v45, v58, v5
    v_and_b32 v46, v59, v4
    v_and_b32 v47, v59, v5
    v_add_f32 v9, v9, v60
    v_add_f32 v9, v9, v61
    v_mfma_f32_16x16x16_bf16 v[32:35], v[176:177], v[40:41], v[32:35]
    v_mfma_f32_16x16x16_bf16 v[36:39], v[178:179], v[40:41], v[36:39]
    v_mfma_f32_16x16x16_bf16 v[32:35], v[180:181], v[42:43], v[32:35]
    v_mfma_f32_16x16x16_bf16 v[36:39], v[182:183], v[42:43], v[36:39]
    v_mfma_f32_16x16x16_bf16 v[32:35], v[184:185], v[44:45], v[32:35]
    v_mfma_f32_16x16x16_bf16 v[36:39], v[186:187], v[44:45], v[36:39]
    v_mfma_f32_16x16x16_bf16 v[32:35], v[188:189], v[46:47], v[32:35]
    v_mfma_f32_16x16x16_bf16 v[36:39], v[190:191], v[46:47], v[36:39]
    s_mov_b32 s79, 2
    s_branch L_k
L_a2:
    v_mfma_f32_16x16x32_bf16 v[40:43], v[192:195], v[12:15], 0
    v_mfma_f32_16x16x32_bf16 v[44:47], v[196:199], v[12:15], 0
    v_mfma_f32_16x16x32_bf16 v[48:51], v[200:203], v[12:15], 0
    v_mfma_f32_16x16x32_bf16 v[52:55], v[204:207], v[12:15], 0
    s_nop 5
    v_mov_b32_dpp v56, v40 quad_perm:[0,0,0,0] row_mask:0xf bank_mask:0xf
    v_mov_b32_dpp v57, v44 quad_perm:[0,0,0,0] row_mask:0xf bank_mask:0xf
    v_mov_b32_dpp v58, v48 quad_perm:[0,0,0,0] row_mask:0xf bank_mask:0xf
    v_mov_b32_dpp v59, v52 quad_perm:[0,0,0,0] row_mask:0xf bank_mask:0xf
    v_add_f32_dpp v56, v41, v56 quad_perm:[1,1,1,1] row_mask:0xf bank_mask:0xf
    v_add_f32_dpp v57, v45, v57 quad_perm:[1,1,1,1] row_mask:0xf bank_mask:0xf
    v_add_f32_dpp v58, v49, v58 quad_perm:[1,1,1,1] row_mask:0xf bank_mask:0xf
    v_add_f32_dpp v59, v53, v59 quad_perm:[1,1,1,1] row_mask:0xf bank_mask:0xf
    v_add_f32_dpp v56, v42, v56 quad_perm:[2,2,2,2] row_mask:0xf bank_mask:0xf
    v_add_f32_dpp v57, v46, v57 quad_perm:[2,2,2,2] row_mask:0xf bank_mask:0xf
    v_add_f32_dpp v58, v50, v58 quad_perm:[2,2,2,2] row_mask:0xf bank_mask:0xf
    v_add_f32_dpp v59, v54, v59 quad_perm:[2,2,2,2] row_mask:0xf bank_mask:0xf
    v_add_f32_dpp v56, v43, v56 quad_perm:[3,3,3,3] row_mask:0xf bank_mask:0xf
    v_add_f32_dpp v57, v47, v57 quad_perm:[3,3,3,3] row_mask:0xf bank_mask:0xf
    v_add_f32_dpp v58, v51, v58 quad_perm:[3,3,3,3] row_mask:0xf bank_mask:0xf
    v_add_f32_dpp v59, v55, v59 quad_perm:[3,3,3,3] row_mask:0xf bank_mask:0xf
    v_max3_f32 v60, v56, v57, v58
    v_max_f32 v60, v60, v59
    v_cmp_gt_f32 vcc, v60, v10
    s_cbranch_vccnz L_rs_39
L_bk_40:
    v_fma_f32 v56, v56, s77, -v8
    v_fma_f32 v57, v57, s77, -v8
    v_fma_f32 v58, v58, s77, -v8
    v_fma_f32 v59, v59, s77, -v8
    v_exp_f32 v56, v56
    v_exp_f32 v57, v57
    v_exp_f32 v58, v58
    v_exp_f32 v59, v59
    v_add_f32 v60, v56, v57
    v_cvt_pk_bf16_f32 v56, v56, v56
    v_add_f32 v61, v58, v59
    v_cvt_pk_bf16_f32 v57, v57, v57
    v_cvt_pk_bf16_f32 v58, v58, v58
    v_cvt_pk_bf16_f32 v59, v59, v59
    v_and_b32 v40, v56, v4
    v_and_b32 v41, v56, v5
    v_and_b32 v42, v57, v4
    v_and_b32 v43, v57, v5
    v_and_b32 v44, v58, v4
    v_and_b32 v45, v58, v5
    v_and_b32 v46, v59, v4
    v_and_b32 v47, v59, v5
    v_add_f32 v9, v9, v60
    v_add_f32 v9, v9, v61
    v_mfma_f32_16x16x16_bf16 v[32:35], v[208:209], v[40:41], v[32:35]
    v_mfma_f32_16x16x16_bf16 v[36:39], v[210:211], v[40:41], v[36:39]
    v_mfma_f32_16x16x16_bf16 v[32:35], v[212:213], v[42:43], v[32:35]
    v_mfma_f32_16x16x16_bf16 v[36:39], v[214:215], v[42:43], v[36:39]
    v_mfma_f32_16x16x16_bf16 v[32:35], v[216:217], v[44:45], v[32:35]
    v_mfma_f32_16x16x16_bf16 v[36:39], v[218:219], v[44:45], v[36:39]
    v_mfma_f32_16x16x16_bf16 v[32:35], v[220:221], v[46:47], v[32:35]
    v_mfma_f32_16x16x16_bf16 v[36:39], v[222:223], v[46:47], v[36:39]
    s_mov_b32 s79, 3
    s_branch L_k
L_a3:
    v_mfma_f32_16x16x32_bf16 v[40:43], v[224:227], v[12:15], 0
    v_mfma_f32_16x16x32_bf16 v[44:47], v[228:231], v[12:15], 0
    v_mfma_f32_16x16x32_bf16 v[48:51], v[232:235], v[12:15], 0
    v_mfma_f32_16x16x32_bf16 v[52:55], v[236:239], v[12:15], 0
    s_nop 5
    v_mov_b32_dpp v56, v40 quad_perm:[0,0,0,0] row_mask:0xf bank_mask:0xf
    v_mov_b32_dpp v57, v44 quad_perm:[0,0,0,0] row_mask:0xf bank_mask:0xf
    v_mov_b32_dpp v58, v48 quad_perm:[0,0,0,0] row_mask:0xf bank_mask:0xf
    v_mov_b32_dpp v59, v52 quad_perm:[0,0,0,0] row_mask:0xf bank_mask:0xf
    v_add_f32_dpp v56, v41, v56 quad_perm:[1,1,1,1] row_mask:0xf bank_mask:0xf
    v_add_f32_dpp v57, v45, v57 quad_perm:[1,1,1,1] row_mask:0xf bank_mask:0xf
    v_add_f32_dpp v58, v49, v58 quad_perm:[1,1,1,1] row_mask:0xf bank_mask:0xf
    v_add_f32_dpp v59, v53, v59 quad_perm:[1,1,1,1] row_mask:0xf bank_mask:0xf
    v_add_f32_dpp v56, v42, v56 quad_perm:[2,2,2,2] row_mask:0xf bank_mask:0xf
    v_add_f32_dpp v57, v46, v57 quad_perm:[2,2,2,2] row_mask:0xf bank_mask:0xf
    v_add_f32_dpp v58, v50, v58 quad_perm:[2,2,2,2] row_mask:0xf bank_mask:0xf
    v_add_f32_dpp v59, v54, v59 quad_perm:[2,2,2,2] row_mask:0xf bank_mask:0xf
    v_add_f32_dpp v56, v43, v56 quad_perm:[3,3,3,3] row_mask:0xf bank_mask:0xf
    v_add_f32_dpp v57, v47, v57 quad_perm:[3,3,3,3] row_mask:0xf bank_mask:0xf
    v_add_f32_dpp v58, v51, v58 quad_perm:[3,3,3,3] row_mask:0xf bank_mask:0xf
    v_add_f32_dpp v59, v55, v59 quad_perm:[3,3,3,3] row_mask:0xf bank_mask:0xf
    v_max3_f32 v60, v56, v57, v58
    v_max_f32 v60, v60, v59
    v_cmp_gt_f32 vcc, v60, v10
    s_cbranch_vccnz L_rs_41
L_bk_42:
    v_fma_f32 v56, v56, s77, -v8
    v_fma_f32 v57, v57, s77, -v8
    v_fma_f32 v58, v58, s77, -v8
    v_fma_f32 v59, v59, s77, -v8
    v_exp_f32 v56, v56
    v_exp_f32 v57, v57
    v_exp_f32 v58, v58
    v_exp_f32 v59, v59
    v_add_f32 v60, v56, v57
    v_cvt_pk_bf16_f32 v56, v56, v56
    v_add_f32 v61, v58, v59
    v_cvt_pk_bf16_f32 v57, v57, v57
    v_cvt_pk_bf16_f32 v58, v58, v58
    v_cvt_pk_bf16_f32 v59, v59, v59
    v_and_b32 v40, v56, v4
    v_and_b32 v41, v56, v5
    v_and_b32 v42, v57, v4
    v_and_b32 v43, v57, v5
    v_and_b32 v44, v58, v4
    v_and_b32 v45, v58, v5
    v_and_b32 v46, v59, v4
    v_and_b32 v47, v59, v5
    v_add_f32 v9, v9, v60
    v_add_f32 v9, v9, v61
    v_mfma_f32_16x16x16_bf16 v[32:35], v[240:241], v[40:41], v[32:35]
    v_mfma_f32_16x16x16_bf16 v[36:39], v[242:243], v[40:41], v[36:39]
    v_mfma_f32_16x16x16_bf16 v[32:35], v[244:245], v[42:43], v[32:35]
    v_mfma_f32_16x16x16_bf16 v[36:39], v[246:247], v[42:43], v[36:39]
    v_mfma_f32_16x16x16_bf16 v[32:35], v[248:249], v[44:45], v[32:35]
    v_mfma_f32_16x16x16_bf16 v[36:39], v[250:251], v[44:45], v[36:39]
    v_mfma_f32_16x16x16_bf16 v[32:35], v[252:253], v[46:47], v[32:35]
    v_mfma_f32_16x16x16_bf16 v[36:39], v[254:255], v[46:47], v[36:39]
    s_mov_b32 s79, 4
    s_mul_i32 s4, s3, 0xc00
    s_add_u32 s4, s4, 4096
    v_lshlrev_b32 v60, 4, v0
    v_lshlrev_b32 v61, 3, v0
    v_add_u32 v60, s4, v60
    v_add_u32 v61, s4, v61
    s_nop 3
    ds_write_b128 v60, v[32:35]
    ds_write_b128 v60, v[36:39] offset:1024
    ds_write_b64 v61, v[8:9] offset:2048
    v_mov_b32 v60, 36
    v_mov_b32 v61, 1
    s_mov_b64 exec, 1
    ds_add_u32 v60, v61
    s_mov_b64 exec, -1
    s_mov_b32 s37, 0
    s_branch L_k
L_kend:
    s_sub_u32 s70, s70, 0x100000
    s_waitcnt vmcnt(12)
    v_mfma_f32_16x16x32_bf16 v[40:43], v[64:67], v[16:19], 0
    v_mfma_f32_16x16x32_bf16 v[40:43], v[68:71], v[20:23], v[40:43]
    v_mfma_f32_16x16x32_bf16 v[40:43], v[72:75], v[24:27], v[40:43]
    v_mfma_f32_16x16x32_bf16 v[40:43], v[76:79], v[28:31], v[40:43]
    s_xor_b32 s73, s70, s74
    s_cmp_gt_i32 s76, 60
    s_cselect_b32 s5, 0x1000, s36
    s_add_u32 s4, s76, 40
    s_cmp_lt_i32 s4, s5
    s_cselect_b64 vcc, -1, 0
    s_max_i32 s4, s76, s5
    s_cmp_gt_i32 s4, 10
    s_cbranch_scc1 L_wa_43
    s_waitcnt vmcnt(4)
    s_cbranch_vccz L_go_44
    s_waitcnt vmcnt(3)
L_wa_43:
    s_cbranch_vccnz L_go_44
    s_waitcnt vmcnt(5)
L_go_44:
    buffer_load_dwordx4 v[64:67], v2, s[12:15], s73 offen offset:0 nt
    s_mov_b64 exec, 1
    ds_add_u32 v2, v3 offset:4
    ds_read_b64 v[58:59], v2 offset:96
    s_mov_b64 exec, -1
    s_memrealtime s[6:7]
    s_waitcnt vmcnt(9)
    v_mfma_f32_16x16x32_bf16 v[44:47], v[80:83], v[16:19], 0
    v_mfma_f32_16x16x32_bf16 v[44:47], v[84:87], v[20:23], v[44:47]
    v_mfma_f32_16x16x32_bf16 v[44:47], v[88:91], v[24:27], v[44:47]
    v_mfma_f32_16x16x32_bf16 v[44:47], v[92:95], v[28:31], v[44:47]
    s_cbranch_scc1 L_wa_45
    s_waitcnt vmcnt(4)
    s_cbranch_vccz L_go_46
    s_waitcnt vmcnt(3)
L_wa_45:
    s_cbranch_vccnz L_go_46
    s_waitcnt vmcnt(5)
L_go_46:
    buffer_load_dwordx4 v[68:71], v2, s[12:15], s73 offen offset:1024 nt
    s_nop 7
    v_mov_b32_dpp v56, v40 quad_perm:[0,0,0,0] row_mask:0xf bank_mask:0xf
    v_mov_b32_dpp v57, v41 quad_perm:[1,1,1,1] row_mask:0xf bank_mask:0xf
    s_nop 0
    v_add_f32_dpp v56, v42, v56 quad_perm:[2,2,2,2] row_mask:0xf bank_mask:0xf
    v_add_f32_dpp v57, v43, v57 quad_perm:[3,3,3,3] row_mask:0xf bank_mask:0xf
    v_add_f32 v56, v56, v57
    v_cndmask_b32 v7, v7, v56, s[28:29]
    s_waitcnt vmcnt(6)
    v_mfma_f32_16x16x32_bf16 v[48:51], v[96:99], v[16:19], 0
    v_mfma_f32_16x16x32_bf16 v[48:51], v[100:103], v[20:23], v[48:51]
    v_mfma_f32_16x16x32_bf16 v[48:51], v[104:107], v[24:27], v[48:51]
    v_mfma_f32_16x16x32_bf16 v[48:51], v[108:111], v[28:31], v[48:51]
    s_cbranch_scc1 L_wa_47
    s_waitcnt vmcnt(4)
    s_cbranch_vccz L_go_48
    s_waitcnt vmcnt(3)
L_wa_47:
    s_cbranch_vccnz L_go_48
    s_waitcnt vmcnt(5)
L_go_48:
    buffer_load_dwordx4 v[72:75], v2, s[12:15], s73 offen offset:2048 nt
    s_waitcnt lgkmcnt(0)
    v_readfirstlane_b32 s76, v58
    v_readfirstlane_b32 s75, v59
    s_nop 7
    v_mov_b32_dpp v56, v44 quad_perm:[0,0,0,0] row_mask:0xf bank_mask:0xf
    v_mov_b32_dpp v57, v45 quad_perm:[1,1,1,1] row_mask:0xf bank_mask:0xf
    s_nop 0
    v_add_f32_dpp v56, v46, v56 quad_perm:[2,2,2,2] row_mask:0xf bank_mask:0xf
    v_add_f32_dpp v57, v47, v57 quad_perm:[3,3,3,3] row_mask:0xf bank_mask:0xf
    v_add_f32 v56, v56, v57
    v_cndmask_b32 v7, v7, v56, s[30:31]
    s_cbranch_scc1 L_wa_49
    s_waitcnt vmcnt(4)
    s_cbranch_vccz L_go_50
    s_waitcnt vmcnt(3)
L_wa_49:
    s_cbranch_vccnz L_go_50
    s_waitcnt vmcnt(5)
L_go_50:
    buffer_load_dwordx4 v[76:79], v2, s[12:15], s73 offen offset:3072 nt
    s_add_u32 s70, s70, 0x4000
    s_add_u32 s71, s71, 1
    s_mul_i32 s4, s75, s71
    s_lshr_b32 s4, s4, 8
    s_add_u32 s76, s76, s4
    s_sub_u32 s76, s6, s76
    s_min_i32 s76, s76, 0x400
    s_cmp_eq_u32 s75, 0
    s_cselect_b32 s76, 0, s76
    s_nop 7
    v_mov_b32_dpp v56, v48 quad_perm:[0,0,0,0] row_mask:0xf bank_mask:0xf
    v_mov_b32_dpp v57, v49 quad_perm:[1,1,1,1] row_mask:0xf bank_mask:0xf
    s_nop 0
    v_add_f32_dpp v56, v50, v56 quad_perm:[2,2,2,2] row_mask:0xf bank_mask:0xf
    v_add_f32_dpp v57, v51, v57 quad_perm:[3,3,3,3] row_mask:0xf bank_mask:0xf
    v_add_f32 v56, v56, v57
    v_cndmask_b32 v7, v7, v56, s[32:33]
    s_waitcnt vmcnt(4)
    v_mfma_f32_16x16x32_bf16 v[52:55], v[112:115], v[16:19], 0
    v_mfma_f32_16x16x32_bf16 v[52:55], v[116:119], v[20:23], v[52:55]
    v_mfma_f32_16x16x32_bf16 v[52:55], v[120:123], v[24:27], v[52:55]
    v_mfma_f32_16x16x32_bf16 v[52:55], v[124:127], v[28:31], v[52:55]
    s_add_u32 s4, s81, 16384
    v_add_u32 v12, s4, v2
    s_lshr_b32 s5, s81, 1
    s_add_u32 s5, s5, 49152
    v_lshlrev_b32 v13, 3, v0
    v_add_u32 v13, s5, v13
    v_lshrrev_b32 v14, 4, v0
    v_lshlrev_b32 v14, 3, v14
    v_add_u32 v14, s5, v14
    s_xor_b32 s73, s70, s74
    s_cmp_gt_i32 s76, 60
    s_cselect_b32 s5, 0x1000, s36
    s_add_u32 s4, s76, 40
    s_cmp_lt_i32 s4, s5
    s_cselect_b64 vcc, -1, 0
    s_max_i32 s4, s76, s5
    s_cmp_gt_i32 s4, 10
    s_cbranch_scc1 L_wa_51
    s_waitcnt vmcnt(4)
    s_cbranch_vccz L_go_52
    s_waitcnt vmcnt(3)
L_wa_51:
    s_cbranch_vccnz L_go_52
    s_waitcnt vmcnt(5)
L_go_52:
    buffer_load_dwordx4 v[80:83], v2, s[12:15], s73 offen offset:0 nt
    s_mov_b64 exec, 1
    ds_add_u32 v2, v3 offset:4
    ds_read_b64 v[58:59], v2 offset:96
    s_mov_b64 exec, -1
    s_memrealtime s[6:7]
    s_nop 7
    v_mov_b32_dpp v56, v52 quad_perm:[0,0,0,0] row_mask:0xf bank_mask:0xf
    v_mov_b32_dpp v57, v53 quad_perm:[1,1,1,1] row_mask:0xf bank_mask:0xf
    s_nop 0
    v_add_f32_dpp v56, v54, v56 quad_perm:[2,2,2,2] row_mask:0xf bank_mask:0xf
    v_add_f32_dpp v57, v55, v57 quad_perm:[3,3,3,3] row_mask:0xf bank_mask:0xf
    v_add_f32 v56, v56, v57
    v_cndmask_b32 v7, v7, v56, s[34:35]
    ds_write_b32 v6, v7
    v_max_f32 v11, v11, v7
    ds_read_b128 v[128:131], v12 offset:0
    ds_read_b128 v[132:135], v12 offset:1024
    ds_read_b128 v[136:139], v12 offset:2048
    ds_read_b128 v[140:143], v12 offset:3072
    s_cbranch_scc1 L_wa_53
    s_waitcnt vmcnt(4)
    s_cbranch_vccz L_go_54
    s_waitcnt vmcnt(3)
L_wa_53:
    s_cbranch_vccnz L_go_54
    s_waitcnt vmcnt(5)
L_go_54:
    buffer_load_dwordx4 v[84:87], v2, s[12:15], s73 offen offset:1024 nt
    s_nop 1
    v_max_f32_dpp v11, v11, v11 quad_perm:[1,0,3,2] row_mask:0xf bank_mask:0xf
    s_nop 1
    v_max_f32_dpp v11, v11, v11 quad_perm:[2,3,0,1] row_mask:0xf bank_mask:0xf
    s_nop 1
    v_max_f32_dpp v11, v11, v11 row_ror:4 row_mask:0xf bank_mask:0xf
    s_nop 1
    v_max_f32_dpp v11, v11, v11 row_ror:8 row_mask:0xf bank_mask:0xf
    v_mov_b32 v60, v11
    s_nop 1
    v_permlane16_swap_b32 v60, v11
    s_nop 0
    v_max_f32 v11, v11, v60
    v_mov_b32 v60, v11
    s_nop 1
    v_permlane32_swap_b32 v60, v11
    s_nop 0
    v_max_f32 v11, v11, v60
    v_mul_f32 v8, s77, v11
    v_mov_b32 v30, v14
    s_cbranch_scc1 L_wa_55
    s_waitcnt vmcnt(4)
    s_cbranch_vccz L_go_56
    s_waitcnt vmcnt(3)
L_wa_55:
    s_cbranch_vccnz L_go_56
    s_waitcnt vmcnt(5)
L_go_56:
    buffer_load_dwordx4 v[88:91], v2, s[12:15], s73 offen offset:2048 nt
    s_waitcnt lgkmcnt(0)
    v_readfirstlane_b32 s76, v58
    v_readfirstlane_b32 s75, v59
    v_fma_f32 v128, v128, s77, -v8
    v_fma_f32 v129, v129, s77, -v8
    v_fma_f32 v130, v130, s77, -v8
    v_fma_f32 v131, v131, s77, -v8
    v_fma_f32 v132, v132, s77, -v8
    v_fma_f32 v133, v133, s77, -v8
    v_fma_f32 v134, v134, s77, -v8
    v_fma_f32 v135, v135, s77, -v8
    v_fma_f32 v136, v136, s77, -v8
    v_fma_f32 v137, v137, s77, -v8
    v_fma_f32 v138, v138, s77, -v8
    v_fma_f32 v139, v139, s77, -v8
    v_fma_f32 v140, v140, s77, -v8
    v_fma_f32 v141, v141, s77, -v8
    v_fma_f32 v142, v142, s77, -v8
    v_fma_f32 v143, v143, s77, -v8
    s_cbranch_scc1 L_wa_57
    s_waitcnt vmcnt(4)
    s_cbranch_vccz L_go_58
    s_waitcnt vmcnt(3)
L_wa_57:
    s_cbranch_vccnz L_go_58
    s_waitcnt vmcnt(5)
L_go_58:
    buffer_load_dwordx4 v[92:95], v2, s[12:15], s73 offen offset:3072 nt
    s_add_u32 s70, s70, 0x4000
    s_add_u32 s71, s71, 1
    s_mul_i32 s4, s75, s71
    s_lshr_b32 s4, s4, 8
    s_add_u32 s76, s76, s4
    s_sub_u32 s76, s6, s76
    s_min_i32 s76, s76, 0x400
    s_cmp_eq_u32 s75, 0
    s_cselect_b32 s76, 0, s76
    v_exp_f32 v128, v128
    v_exp_f32 v129, v129
    v_exp_f32 v130, v130
    v_exp_f32 v131, v131
    v_exp_f32 v132, v132
    v_exp_f32 v133, v133
    v_exp_f32 v134, v134
    v_exp_f32 v135, v135
    v_exp_f32 v136, v136
    v_exp_f32 v137, v137
    v_exp_f32 v138, v138
    v_exp_f32 v139, v139
    v_exp_f32 v140, v140
    v_exp_f32 v141, v141
    v_exp_f32 v142, v142
    v_exp_f32 v143, v143
    s_xor_b32 s73, s70, s74
    s_cmp_gt_i32 s76, 60
    s_cselect_b32 s5, 0x1000, s36
    s_add_u32 s4, s76, 40
    s_cmp_lt_i32 s4, s5
    s_cselect_b64 vcc, -1, 0
    s_max_i32 s4, s76, s5
    s_cmp_gt_i32 s4, 10
    s_cbranch_scc1 L_wa_59
    s_waitcnt vmcnt(4)
    s_cbranch_vccz L_go_60
    s_waitcnt vmcnt(3)
L_wa_59:
    s_cbranch_vccnz L_go_60
    s_waitcnt vmcnt(5)
L_go_60:
    buffer_load_dwordx4 v[96:99], v2, s[12:15], s73 offen offset:0 nt
    s_mov_b64 exec, 1
    ds_add_u32 v2, v3 offset:4
    ds_read_b64 v[58:59], v2 offset:96
    s_mov_b64 exec, -1
    s_memrealtime s[6:7]
    v_cvt_pk_bf16_f32 v144, v128, v129
    v_cvt_pk_bf16_f32 v145, v130, v131
    v_cvt_pk_bf16_f32 v146, v132, v133
    v_cvt_pk_bf16_f32 v147, v134, v135
    v_cvt_pk_bf16_f32 v148, v136, v137
    v_cvt_pk_bf16_f32 v149, v138, v139
    v_cvt_pk_bf16_f32 v150, v140, v141
    v_cvt_pk_bf16_f32 v151, v142, v143
    ds_write_b64 v13, v[144:145] offset:0
    ds_write_b64 v13, v[146:147] offset:512
    ds_write_b64 v13, v[148:149] offset:1024
    ds_write_b64 v13, v[150:151] offset:1536
    ds_read_b64 v[56:57], v30
    s_cbranch_scc1 L_wa_61
    s_waitcnt vmcnt(4)
    s_cbranch_vccz L_go_62
    s_waitcnt vmcnt(3)
L_wa_61:
    s_cbranch_vccnz L_go_62
    s_waitcnt vmcnt(5)
L_go_62:
    buffer_load_dwordx4 v[100:103], v2, s[12:15], s73 offen offset:1024 nt
    v_add_f32 v48, v128, v132
    v_add_f32 v49, v129, v133
    v_add_f32 v50, v130, v134
    v_add_f32 v51, v131, v135
    v_add_f32 v48, v48, v136
    v_add_f32 v49, v49, v137
    v_add_f32 v50, v50, v138
    v_add_f32 v51, v51, v139
    v_add_f32 v48, v48, v140
    v_add_f32 v49, v49, v141
    v_add_f32 v50, v50, v142
    v_add_f32 v51, v51, v143
    v_add_f32 v48, v48, v49
    v_add_f32 v50, v50, v51
    v_add_f32 v9, v48, v50
    s_cbranch_scc1 L_wa_63
    s_waitcnt vmcnt(4)
    s_cbranch_vccz L_go_64
    s_waitcnt vmcnt(3)
L_wa_63:
    s_cbranch_vccnz L_go_64
    s_waitcnt vmcnt(5)
L_go_64:
    buffer_load_dwordx4 v[104:107], v2, s[12:15], s73 offen offset:2048 nt
    s_waitcnt lgkmcnt(0)
    v_readfirstlane_b32 s76, v58
    v_readfirstlane_b32 s75, v59
    s_nop 1
    v_add_f32_dpp v9, v9, v9 quad_perm:[1,0,3,2] row_mask:0xf bank_mask:0xf
    s_nop 1
    v_add_f32_dpp v9, v9, v9 quad_perm:[2,3,0,1] row_mask:0xf bank_mask:0xf
    s_nop 1
    v_add_f32_dpp v9, v9, v9 row_ror:4 row_mask:0xf bank_mask:0xf
    s_nop 1
    v_add_f32_dpp v9, v9, v9 row_ror:8 row_mask:0xf bank_mask:0xf
    v_mov_b32 v60, v9
    s_nop 1
    v_permlane16_swap_b32 v60, v9
    s_nop 0
    v_add_f32 v9, v9, v60
    v_mov_b32 v60, v9
    s_nop 1
    v_permlane32_swap_b32 v60, v9
    s_nop 0
    v_add_f32 v9, v9, v60
    v_max_u32 v9, 1, v9
    s_cbranch_scc1 L_wa_65
    s_waitcnt vmcnt(4)
    s_cbranch_vccz L_go_66
    s_waitcnt vmcnt(3)
L_wa_65:
    s_cbranch_vccnz L_go_66
    s_waitcnt vmcnt(5)
L_go_66:
    buffer_load_dwordx4 v[108:111], v2, s[12:15], s73 offen offset:3072 nt
    s_add_u32 s70, s70, 0x4000
    s_add_u32 s71, s71, 1
    s_mul_i32 s4, s75, s71
    s_lshr_b32 s4, s4, 8
    s_add_u32 s76, s76, s4
    s_sub_u32 s76, s6, s76
    s_min_i32 s76, s76, 0x400
    s_cmp_eq_u32 s75, 0
    s_cselect_b32 s76, 0, s76
    s_lshl_b32 s4, s3, 3
    v_mov_b32 v60, s4
    v_mov_b32 v31, 0
    s_mov_b64 exec, 1
    ds_write_b64 v60, v[8:9] offset:64
    s_mov_b64 exec, -1
    v_and_b32 v11, 31, v0
    v_lshlrev_b32 v11, 2, v11
    v_bfe_i32 v61, v0, 5, 1
    v_and_b32 v61, 0x8180, v61
    v_xor_b32 v11, v11, v61
    s_add_u32 s4, s81, 16384
    v_and_b32 v28, 3, v0
    v_lshrrev_b32 v29, 4, v0
    v_lshl_add_u32 v28, v29, 2, v28
    v_lshlrev_b32 v28, 5, v28
    v_add_u32 v28, s4, v28
    v_lshlrev_b32 v29, 3, v0
    s_lshl_b32 s5, s2, 7
    v_xor_b32 v11, s5, v11
    s_mov_b32 s80, 8388608
    s_xor_b32 s73, s70, s74
    s_cmp_gt_i32 s76, 60
    s_cselect_b32 s5, 0x1000, s36
    s_add_u32 s4, s76, 40
    s_cmp_lt_i32 s4, s5
    s_cselect_b64 vcc, -1, 0
    s_max_i32 s4, s76, s5
    s_cmp_gt_i32 s4, 10
    s_cbranch_scc1 L_wa_67
    s_waitcnt vmcnt(4)
    s_cbranch_vccz L_go_68
    s_waitcnt vmcnt(3)
L_wa_67:
    s_cbranch_vccnz L_go_68
    s_waitcnt vmcnt(5)
L_go_68:
    buffer_load_dwordx4 v[112:115], v2, s[12:15], s73 offen offset:0 nt
    s_mov_b64 exec, 1
    ds_add_u32 v2, v3 offset:4
    ds_read_b64 v[58:59], v2 offset:96
    s_mov_b64 exec, -1
    s_memrealtime s[6:7]
    v_mov_b32 v60, 0x0c0c0c0c
    s_mov_b32 s4, 0x1000100
    v_bfi_b32 v16, v4, s4, v60
    v_bfi_b32 v17, v5, s4, v60
    s_mov_b32 s4, 0x3020302
    v_bfi_b32 v18, v4, s4, v60
    v_bfi_b32 v19, v5, s4, v60
    s_mov_b32 s4, 0x5040504
    v_bfi_b32 v20, v4, s4, v60
    v_bfi_b32 v21, v5, s4, v60
    s_mov_b32 s4, 0x7060706
    v_bfi_b32 v22, v4, s4, v60
    v_bfi_b32 v23, v5, s4, v60
    s_cbranch_scc1 L_wa_69
    s_waitcnt vmcnt(4)
    s_cbranch_vccz L_go_70
    s_waitcnt vmcnt(3)
L_wa_69:
    s_cbranch_vccnz L_go_70
    s_waitcnt vmcnt(5)
L_go_70:
    buffer_load_dwordx4 v[116:119], v2, s[12:15], s73 offen offset:1024 nt
    v_mov_b32 v32, 0
    v_mov_b32 v33, 0
    v_mov_b32 v34, 0
    v_mov_b32 v35, 0
    v_mov_b32 v36, 0
    v_mov_b32 v37, 0
    v_mov_b32 v38, 0
    v_mov_b32 v39, 0
    s_cbranch_scc1 L_wa_71
    s_waitcnt vmcnt(4)
    s_cbranch_vccz L_go_72
    s_waitcnt vmcnt(3)
L_wa_71:
    s_cbranch_vccnz L_go_72
    s_waitcnt vmcnt(5)
L_go_72:
    buffer_load_dwordx4 v[120:123], v2, s[12:15], s73 offen offset:2048 nt
    s_waitcnt lgkmcnt(0)
    v_readfirstlane_b32 s76, v58
    v_readfirstlane_b32 s75, v59
    v_perm_b32 v40, v57, v56, v16
    v_perm_b32 v41, v57, v56, v17
    v_perm_b32 v42, v57, v56, v18
    v_perm_b32 v43, v57, v56, v19
    v_perm_b32 v44, v57, v56, v20
    v_perm_b32 v45, v57, v56, v21
    v_perm_b32 v46, v57, v56, v22
    v_perm_b32 v47, v57, v56, v23
    s_cbranch_scc1 L_wa_73
    s_waitcnt vmcnt(4)
    s_cbranch_vccz L_go_74
    s_waitcnt vmcnt(3)
L_wa_73:
    s_cbranch_vccnz L_go_74
    s_waitcnt vmcnt(5)
L_go_74:
    buffer_load_dwordx4 v[124:127], v2, s[12:15], s73 offen offset:3072 nt
    s_add_u32 s70, s70, 0x4000
    s_add_u32 s71, s71, 1
    s_mul_i32 s4, s75, s71
    s_lshr_b32 s4, s4, 8
    s_add_u32 s76, s76, s4
    s_sub_u32 s76, s6, s76
    s_min_i32 s76, s76, 0x400
    s_cmp_eq_u32 s75, 0
    s_cselect_b32 s76, 0, s76
L_v:
    ds_read_b64 v[56:57], v30 offset:32
    s_xor_b32 s73, s70, s74
    s_cmp_gt_i32 s76, 60
    s_cselect_b32 s5, 0x1000, s36
    s_add_u32 s4, s76, 40
    s_cmp_lt_i32 s4, s5
    s_cselect_b64 vcc, -1, 0
    s_max_i32 s4, s76, s5
    s_cmp_gt_i32 s4, 10
    s_waitcnt vmcnt(12)
    v_mfma_f32_16x16x16_bf16 v[32:35], v[64:65], v[40:41], v[32:35]
    v_mfma_f32_16x16x16_bf16 v[36:39], v[66:67], v[40:41], v[36:39]
    v_mfma_f32_16x16x16_bf16 v[32:35], v[68:69], v[42:43], v[32:35]
    v_mfma_f32_16x16x16_bf16 v[36:39], v[70:71], v[42:43], v[36:39]
    v_mfma_f32_16x16x16_bf16 v[32:35], v[72:73], v[44:45], v[32:35]
    v_mfma_f32_16x16x16_bf16 v[36:39], v[74:75], v[44:45], v[36:39]
    v_mfma_f32_16x16x16_bf16 v[32:35], v[76:77], v[46:47], v[32:35]
    v_mfma_f32_16x16x16_bf16 v[36:39], v[78:79], v[46:47], v[36:39]
    s_cbranch_scc1 L_wa_75
    s_waitcnt vmcnt(4)
    s_cbranch_vccz L_go_76
    s_waitcnt vmcnt(3)
L_wa_75:
    s_cbranch_vccnz L_go_76
    s_waitcnt vmcnt(5)
L_go_76:
    buffer_load_dwordx4 v[64:67], v2, s[12:15], s73 offen offset:0 nt
    s_mov_b64 exec, 1
    ds_add_u32 v2, v3 offset:4
    ds_read_b64 v[58:59], v2 offset:96
    s_mov_b64 exec, -1
    s_memrealtime s[6:7]
    s_cbranch_scc1 L_wa_77
    s_waitcnt vmcnt(4)
    s_cbranch_vccz L_go_78
    s_waitcnt vmcnt(3)
L_wa_77:
    s_cbranch_vccnz L_go_78
    s_waitcnt vmcnt(5)
L_go_78:
    buffer_load_dwordx4 v[68:71], v2, s[12:15], s73 offen offset:1024 nt
    s_cbranch_scc1 L_wa_79
    s_waitcnt vmcnt(4)
    s_cbranch_vccz L_go_80
    s_waitcnt vmcnt(3)
L_wa_79:
    s_cbranch_vccnz L_go_80
    s_waitcnt vmcnt(5)
L_go_80:
    buffer_load_dwordx4 v[72:75], v2, s[12:15], s73 offen offset:2048 nt
    s_waitcnt lgkmcnt(0)
    v_readfirstlane_b32 s76, v58
    v_readfirstlane_b32 s75, v59
    v_perm_b32 v40, v57, v56, v16
    v_perm_b32 v41, v57, v56, v17
    v_perm_b32 v42, v57, v56, v18
    v_perm_b32 v43, v57, v56, v19
    v_perm_b32 v44, v57, v56, v20
    v_perm_b32 v45, v57, v56, v21
    v_perm_b32 v46, v57, v56, v22
    v_perm_b32 v47, v57, v56, v23
    s_cbranch_scc1 L_wa_81
    s_waitcnt vmcnt(4)
    s_cbranch_vccz L_go_82
    s_waitcnt vmcnt(3)
L_wa_81:
    s_cbranch_vccnz L_go_82
    s_waitcnt vmcnt(5)
L_go_82:
    buffer_load_dwordx4 v[76:79], v2, s[12:15], s73 offen offset:3072 nt
    s_add_u32 s70, s70, 0x4000
    s_add_u32 s71, s71, 1
    s_mul_i32 s4, s75, s71
    s_lshr_b32 s4, s4, 8
    s_add_u32 s76, s76, s4
    s_sub_u32 s76, s6, s76
    s_min_i32 s76, s76, 0x400
    s_cmp_eq_u32 s75, 0
    s_cselect_b32 s76, 0, s76
    ds_read_b64 v[56:57], v30 offset:64
    s_xor_b32 s73, s70, s74
    s_cmp_gt_i32 s76, 60
    s_cselect_b32 s5, 0x1000, s36
    s_add_u32 s4, s76, 40
    s_cmp_lt_i32 s4, s5
    s_cselect_b64 vcc, -1, 0
    s_max_i32 s4, s76, s5
    s_cmp_gt_i32 s4, 10
    s_waitcnt vmcnt(12)
    v_mfma_f32_16x16x16_bf16 v[32:35], v[80:81], v[40:41], v[32:35]
    v_mfma_f32_16x16x16_bf16 v[36:39], v[82:83], v[40:41], v[36:39]
    v_mfma_f32_16x16x16_bf16 v[32:35], v[84:85], v[42:43], v[32:35]
    v_mfma_f32_16x16x16_bf16 v[36:39], v[86:87], v[42:43], v[36:39]
    v_mfma_f32_16x16x16_bf16 v[32:35], v[88:89], v[44:45], v[32:35]
    v_mfma_f32_16x16x16_bf16 v[36:39], v[90:91], v[44:45], v[36:39]
    v_mfma_f32_16x16x16_bf16 v[32:35], v[92:93], v[46:47], v[32:35]
    v_mfma_f32_16x16x16_bf16 v[36:39], v[94:95], v[46:47], v[36:39]
    s_cbranch_scc1 L_wa_83
    s_waitcnt vmcnt(4)
    s_cbranch_vccz L_go_84
    s_waitcnt vmcnt(3)
L_wa_83:
    s_cbranch_vccnz L_go_84
    s_waitcnt vmcnt(5)
L_go_84:
    buffer_load_dwordx4 v[80:83], v2, s[12:15], s73 offen offset:0 nt
    s_mov_b64 exec, 1
    ds_add_u32 v2, v3 offset:4
    ds_read_b64 v[58:59], v2 offset:96
    s_mov_b64 exec, -1
    s_memrealtime s[6:7]
    s_cbranch_scc1 L_wa_85
    s_waitcnt vmcnt(4)
    s_cbranch_vccz L_go_86
    s_waitcnt vmcnt(3)
L_wa_85:
    s_cbranch_vccnz L_go_86
    s_waitcnt vmcnt(5)
L_go_86:
    buffer_load_dwordx4 v[84:87], v2, s[12:15], s73 offen offset:1024 nt
    s_cbranch_scc1 L_wa_87
    s_waitcnt vmcnt(4)
    s_cbranch_vccz L_go_88
    s_waitcnt vmcnt(3)
L_wa_87:
    s_cbranch_vccnz L_go_88
    s_waitcnt vmcnt(5)
L_go_88:
    buffer_load_dwordx4 v[88:91], v2, s[12:15], s73 offen offset:2048 nt
    s_waitcnt lgkmcnt(0)
    v_readfirstlane_b32 s76, v58
    v_readfirstlane_b32 s75, v59
    v_perm_b32 v40, v57, v56, v16
    v_perm_b32 v41, v57, v56, v17
    v_perm_b32 v42, v57, v56, v18
    v_perm_b32 v43, v57, v56, v19
    v_perm_b32 v44, v57, v56, v20
    v_perm_b32 v45, v57, v56, v21
    v_perm_b32 v46, v57, v56, v22
    v_perm_b32 v47, v57, v56, v23
    s_cbranch_scc1 L_wa_89
    s_waitcnt vmcnt(4)
    s_cbranch_vccz L_go_90
    s_waitcnt vmcnt(3)
L_wa_89:
    s_cbranch_vccnz L_go_90
    s_waitcnt vmcnt(5)
L_go_90:
    buffer_load_dwordx4 v[92:95], v2, s[12:15], s73 offen offset:3072 nt
    s_add_u32 s70, s70, 0x4000
    s_add_u32 s71, s71, 1
    s_mul_i32 s4, s75, s71
    s_lshr_b32 s4, s4, 8
    s_add_u32 s76, s76, s4
    s_sub_u32 s76, s6, s76
    s_min_i32 s76, s76, 0x400
    s_cmp_eq_u32 s75, 0
    s_cselect_b32 s76, 0, s76
    ds_read_b64 v[56:57], v30 offset:96
    s_xor_b32 s73, s70, s74
    s_cmp_gt_i32 s76, 60
    s_cselect_b32 s5, 0x1000, s36
    s_add_u32 s4, s76, 40
    s_cmp_lt_i32 s4, s5
    s_cselect_b64 vcc, -1, 0
    s_max_i32 s4, s76, s5
    s_cmp_gt_i32 s4, 10
    s_waitcnt vmcnt(12)
    v_mfma_f32_16x16x16_bf16 v[32:35], v[96:97], v[40:41], v[32:35]
    v_mfma_f32_16x16x16_bf16 v[36:39], v[98:99], v[40:41], v[36:39]
    v_mfma_f32_16x16x16_bf16 v[32:35], v[100:101], v[42:43], v[32:35]
    v_mfma_f32_16x16x16_bf16 v[36:39], v[102:103], v[42:43], v[36:39]
    v_mfma_f32_16x16x16_bf16 v[32:35], v[104:105], v[44:45], v[32:35]
    v_mfma_f32_16x16x16_bf16 v[36:39], v[106:107], v[44:45], v[36:39]
    v_mfma_f32_16x16x16_bf16 v[32:35], v[108:109], v[46:47], v[32:35]
    v_mfma_f32_16x16x16_bf16 v[36:39], v[110:111], v[46:47], v[36:39]
    s_cbranch_scc1 L_wa_91
    s_waitcnt vmcnt(4)
    s_cbranch_vccz L_go_92
    s_waitcnt vmcnt(3)
L_wa_91:
    s_cbranch_vccnz L_go_92
    s_waitcnt vmcnt(5)
L_go_92:
    buffer_load_dwordx4 v[96:99], v2, s[12:15], s73 offen offset:0 nt
    s_mov_b64 exec, 1
    ds_add_u32 v2, v3 offset:4
    ds_read_b64 v[58:59], v2 offset:96
    s_mov_b64 exec, -1
    s_memrealtime s[6:7]
    s_cbranch_scc1 L_wa_93
    s_waitcnt vmcnt(4)
    s_cbranch_vccz L_go_94
    s_waitcnt vmcnt(3)
L_wa_93:
    s_cbranch_vccnz L_go_94
    s_waitcnt vmcnt(5)
L_go_94:
    buffer_load_dwordx4 v[100:103], v2, s[12:15], s73 offen offset:1024 nt
    s_cbranch_scc1 L_wa_95
    s_waitcnt vmcnt(4)
    s_cbranch_vccz L_go_96
    s_waitcnt vmcnt(3)
L_wa_95:
    s_cbranch_vccnz L_go_96
    s_waitcnt vmcnt(5)
L_go_96:
    buffer_load_dwordx4 v[104:107], v2, s[12:15], s73 offen offset:2048 nt
    s_waitcnt lgkmcnt(0)
    v_readfirstlane_b32 s76, v58
    v_readfirstlane_b32 s75, v59
    v_perm_b32 v40, v57, v56, v16
    v_perm_b32 v41, v57, v56, v17
    v_perm_b32 v42, v57, v56, v18
    v_perm_b32 v43, v57, v56, v19
    v_perm_b32 v44, v57, v56, v20
    v_perm_b32 v45, v57, v56, v21
    v_perm_b32 v46, v57, v56, v22
    v_perm_b32 v47, v57, v56, v23
    s_cbranch_scc1 L_wa_97
    s_waitcnt vmcnt(4)
    s_cbranch_vccz L_go_98
    s_waitcnt vmcnt(3)
L_wa_97:
    s_cbranch_vccnz L_go_98
    s_waitcnt vmcnt(5)
L_go_98:
    buffer_load_dwordx4 v[108:111], v2, s[12:15], s73 offen offset:3072 nt
    s_add_u32 s70, s70, 0x4000
    s_add_u32 s71, s71, 1
    s_mul_i32 s4, s75, s71
    s_lshr_b32 s4, s4, 8
    s_add_u32 s76, s76, s4
    s_sub_u32 s76, s6, s76
    s_min_i32 s76, s76, 0x400
    s_cmp_eq_u32 s75, 0
    s_cselect_b32 s76, 0, s76
    ds_read_b64 v[56:57], v30 offset:128
    s_xor_b32 s73, s70, s74
    s_cmp_gt_i32 s76, 60
    s_cselect_b32 s5, 0x1000, s36
    s_add_u32 s4, s76, 40
    s_cmp_lt_i32 s4, s5
    s_cselect_b64 vcc, -1, 0
    s_max_i32 s4, s76, s5
    s_cmp_gt_i32 s4, 10
    s_waitcnt vmcnt(12)
    v_mfma_f32_16x16x16_bf16 v[32:35], v[112:113], v[40:41], v[32:35]
    v_mfma_f32_16x16x16_bf16 v[36:39], v[114:115], v[40:41], v[36:39]
    v_mfma_f32_16x16x16_bf16 v[32:35], v[116:117], v[42:43], v[32:35]
    v_mfma_f32_16x16x16_bf16 v[36:39], v[118:119], v[42:43], v[36:39]
    v_mfma_f32_16x16x16_bf16 v[32:35], v[120:121], v[44:45], v[32:35]
    v_mfma_f32_16x16x16_bf16 v[36:39], v[122:123], v[44:45], v[36:39]
    v_mfma_f32_16x16x16_bf16 v[32:35], v[124:125], v[46:47], v[32:35]
    v_mfma_f32_16x16x16_bf16 v[36:39], v[126:127], v[46:47], v[36:39]
    s_cbranch_scc1 L_wa_99
    s_waitcnt vmcnt(4)
    s_cbranch_vccz L_go_100
    s_waitcnt vmcnt(3)
L_wa_99:
    s_cbranch_vccnz L_go_100
    s_waitcnt vmcnt(5)
L_go_100:
    buffer_load_dwordx4 v[112:115], v2, s[12:15], s73 offen offset:0 nt
    s_mov_b64 exec, 1
    ds_add_u32 v2, v3 offset:4
    ds_read_b64 v[58:59], v2 offset:96
    s_mov_b64 exec, -1
    s_memrealtime s[6:7]
    s_cbranch_scc1 L_wa_101
    s_waitcnt vmcnt(4)
    s_cbranch_vccz L_go_102
    s_waitcnt vmcnt(3)
L_wa_101:
    s_cbranch_vccnz L_go_102
    s_waitcnt vmcnt(5)
L_go_102:
    buffer_load_dwordx4 v[116:119], v2, s[12:15], s73 offen offset:1024 nt
    s_cbranch_scc1 L_wa_103
    s_waitcnt vmcnt(4)
    s_cbranch_vccz L_go_104
    s_waitcnt vmcnt(3)
L_wa_103:
    s_cbranch_vccnz L_go_104
    s_waitcnt vmcnt(5)
L_go_104:
    buffer_load_dwordx4 v[120:123], v2, s[12:15], s73 offen offset:2048 nt
    s_waitcnt lgkmcnt(0)
    v_readfirstlane_b32 s76, v58
    v_readfirstlane_b32 s75, v59
    v_perm_b32 v40, v57, v56, v16
    v_perm_b32 v41, v57, v56, v17
    v_perm_b32 v42, v57, v56, v18
    v_perm_b32 v43, v57, v56, v19
    v_perm_b32 v44, v57, v56, v20
    v_perm_b32 v45, v57, v56, v21
    v_perm_b32 v46, v57, v56, v22
    v_perm_b32 v47, v57, v56, v23
    s_cbranch_scc1 L_wa_105
    s_waitcnt vmcnt(4)
    s_cbranch_vccz L_go_106
    s_waitcnt vmcnt(3)
L_wa_105:
    s_cbranch_vccnz L_go_106
    s_waitcnt vmcnt(5)
L_go_106:
    buffer_load_dwordx4 v[124:127], v2, s[12:15], s73 offen offset:3072 nt
    s_add_u32 s70, s70, 0x4000
    s_add_u32 s71, s71, 1
    s_mul_i32 s4, s75, s71
    s_lshr_b32 s4, s4, 8
    s_add_u32 s76, s76, s4
    s_sub_u32 s76, s6, s76
    s_min_i32 s76, s76, 0x400
    s_cmp_eq_u32 s75, 0
    s_cselect_b32 s76, 0, s76
    v_add_u32 v30, 0x80, v30
    s_cmp_lt_u32 s71, 128
    s_cbranch_scc1 L_v
    s_mov_b64 exec, 1
    ds_add_u32 v2, v3 offset:4
    s_mov_b64 exec, -1
L_ml:
    ds_read_b128 v[48:51], v31 offset:64
    ds_read_b128 v[52:55], v31 offset:80
    s_waitcnt lgkmcnt(0)
    v_min3_u32 v60, v49, v51, v53
    v_min_u32 v60, v60, v55
    v_cmp_eq_u32 vcc, 0, v60
    s_cbranch_vccz L_ml_ok
    s_sub_u32 s82, s82, 1
    s_cmp_lg_u32 s82, 0
    s_cbranch_scc1 L_ml
    s_endpgm
L_ml_ok:
    ds_read_b64 v[56:57], v30 offset:32
    s_waitcnt vmcnt(12)
    v_mfma_f32_16x16x16_bf16 v[32:35], v[64:65], v[40:41], v[32:35]
    v_mfma_f32_16x16x16_bf16 v[36:39], v[66:67], v[40:41], v[36:39]
    v_mfma_f32_16x16x16_bf16 v[32:35], v[68:69], v[42:43], v[32:35]
    v_mfma_f32_16x16x16_bf16 v[36:39], v[70:71], v[42:43], v[36:39]
    v_mfma_f32_16x16x16_bf16 v[32:35], v[72:73], v[44:45], v[32:35]
    v_mfma_f32_16x16x16_bf16 v[36:39], v[74:75], v[44:45], v[36:39]
    v_mfma_f32_16x16x16_bf16 v[32:35], v[76:77], v[46:47], v[32:35]
    v_mfma_f32_16x16x16_bf16 v[36:39], v[78:79], v[46:47], v[36:39]
    s_waitcnt lgkmcnt(0)
    v_perm_b32 v40, v57, v56, v16
    v_perm_b32 v41, v57, v56, v17
    v_perm_b32 v42, v57, v56, v18
    v_perm_b32 v43, v57, v56, v19
    v_perm_b32 v44, v57, v56, v20
    v_perm_b32 v45, v57, v56, v21
    v_perm_b32 v46, v57, v56, v22
    v_perm_b32 v47, v57, v56, v23
    v_max3_f32 v60, v48, v50, v52
    v_max_f32 v60, v60, v54
    v_sub_f32 v48, v48, v60
    v_sub_f32 v50, v50, v60
    v_sub_f32 v52, v52, v60
    v_sub_f32 v54, v54, v60
    v_sub_f32 v8, v8, v60
    v_exp_f32 v48, v48
    v_exp_f32 v50, v50
    v_exp_f32 v52, v52
    v_exp_f32 v54, v54
    v_exp_f32 v8, v8
    v_mul_f32 v9, v48, v49
    v_fmac_f32 v9, v50, v51
    v_fmac_f32 v9, v52, v53
    v_fmac_f32 v9, v54, v55
    v_rcp_f32 v9, v9
    s_nop 0
    v_mul_f32 v48, v48, v9
    v_mul_f32 v50, v50, v9
    v_mul_f32 v52, v52, v9
    v_mul_f32 v54, v54, v9
    ds_read_b64 v[56:57], v30 offset:64
    s_waitcnt vmcnt(8)
    v_mfma_f32_16x16x16_bf16 v[32:35], v[80:81], v[40:41], v[32:35]
    v_mfma_f32_16x16x16_bf16 v[36:39], v[82:83], v[40:41], v[36:39]
    v_mfma_f32_16x16x16_bf16 v[32:35], v[84:85], v[42:43], v[32:35]
    v_mfma_f32_16x16x16_bf16 v[36:39], v[86:87], v[42:43], v[36:39]
    v_mfma_f32_16x16x16_bf16 v[32:35], v[88:89], v[44:45], v[32:35]
    v_mfma_f32_16x16x16_bf16 v[36:39], v[90:91], v[44:45], v[36:39]
    v_mfma_f32_16x16x16_bf16 v[32:35], v[92:93], v[46:47], v[32:35]
    v_mfma_f32_16x16x16_bf16 v[36:39], v[94:95], v[46:47], v[36:39]
    s_waitcnt lgkmcnt(0)
    v_perm_b32 v40, v57, v56, v16
    v_perm_b32 v41, v57, v56, v17
    v_perm_b32 v42, v57, v56, v18
    v_perm_b32 v43, v57, v56, v19
    v_perm_b32 v44, v57, v56, v20
    v_perm_b32 v45, v57, v56, v21
    v_perm_b32 v46, v57, v56, v22
    v_perm_b32 v47, v57, v56, v23
    ds_read_b64 v[56:57], v30 offset:96
    s_waitcnt vmcnt(4)
    v_mfma_f32_16x16x16_bf16 v[32:35], v[96:97], v[40:41], v[32:35]
    v_mfma_f32_16x16x16_bf16 v[36:39], v[98:99], v[40:41], v[36:39]
    v_mfma_f32_16x16x16_bf16 v[32:35], v[100:101], v[42:43], v[32:35]
    v_mfma_f32_16x16x16_bf16 v[36:39], v[102:103], v[42:43], v[36:39]
    v_mfma_f32_16x16x16_bf16 v[32:35], v[104:105], v[44:45], v[32:35]
    v_mfma_f32_16x16x16_bf16 v[36:39], v[106:107], v[44:45], v[36:39]
    v_mfma_f32_16x16x16_bf16 v[32:35], v[108:109], v[46:47], v[32:35]
    v_mfma_f32_16x16x16_bf16 v[36:39], v[110:111], v[46:47], v[36:39]
    s_waitcnt lgkmcnt(0)
    v_perm_b32 v40, v57, v56, v16
    v_perm_b32 v41, v57, v56, v17
    v_perm_b32 v42, v57, v56, v18
    v_perm_b32 v43, v57, v56, v19
    v_perm_b32 v44, v57, v56, v20
    v_perm_b32 v45, v57, v56, v21
    v_perm_b32 v46, v57, v56, v22
    v_perm_b32 v47, v57, v56, v23
    s_nop 0
    s_waitcnt vmcnt(3)
    v_mfma_f32_16x16x16_bf16 v[32:35], v[112:113], v[40:41], v[32:35]
    v_mfma_f32_16x16x16_bf16 v[36:39], v[114:115], v[40:41], v[36:39]
    s_waitcnt vmcnt(2)
    v_mfma_f32_16x16x16_bf16 v[32:35], v[116:117], v[42:43], v[32:35]
    v_mfma_f32_16x16x16_bf16 v[36:39], v[118:119], v[42:43], v[36:39]
    s_waitcnt vmcnt(1)
    v_mfma_f32_16x16x16_bf16 v[32:35], v[120:121], v[44:45], v[32:35]
    v_mfma_f32_16x16x16_bf16 v[36:39], v[122:123], v[44:45], v[36:39]
    s_waitcnt vmcnt(0)
    v_mfma_f32_16x16x16_bf16 v[32:35], v[124:125], v[46:47], v[32:35]
    v_mfma_f32_16x16x16_bf16 v[36:39], v[126:127], v[46:47], v[36:39]
    s_mov_b32 exec_lo, 0x000f000f
    s_mov_b32 exec_hi, 0x000f000f
    s_nop 4
    ds_write_b128 v28, v[32:35]
    ds_write_b128 v28, v[36:39] offset:16
    s_mov_b64 exec, 1
    ds_add_rtn_u32 v60, v31, v3 offset:40
    s_mov_b64 exec, -1
    ds_read_b64 v[40:41], v29 offset:16384
    ds_read_b64 v[42:43], v29 offset:20480
    ds_read_b64 v[44:45], v29 offset:24576
    ds_read_b64 v[46:47], v29 offset:28672
    s_waitcnt lgkmcnt(4)
    v_readfirstlane_b32 s4, v60
    v_mov_b32 v3, 4
    s_cmp_lg_u32 s4, 3
    s_cbranch_scc1 L_npub
    s_waitcnt lgkmcnt(3)
    v_pk_mul_f32 v[40:41], v[40:41], v[48:49] op_sel_hi:[1,0]
    s_waitcnt lgkmcnt(2)
    v_pk_fma_f32 v[40:41], v[42:43], v[50:51], v[40:41] op_sel_hi:[1,0,1]
    s_waitcnt lgkmcnt(1)
    v_pk_fma_f32 v[40:41], v[44:45], v[52:53], v[40:41] op_sel_hi:[1,0,1]
    s_waitcnt lgkmcnt(0)
    v_pk_fma_f32 v[40:41], v[46:47], v[54:55], v[40:41] op_sel_hi:[1,0,1]
    s_nop 0
    v_cvt_pk_bf16_f32 v40, v40, v41
    v_min_u32 v40, -2, v40
    buffer_store_dword v40, v11, s[24:27], s80 offen sc1
    s_mov_b64 exec, 1
    ds_add_u32 v2, v3 offset:4
    s_mov_b64 exec, -1
L_npub:
    s_endpgm
L_helper:
    s_setprio 3
    s_sub_u32 s66, s3, 4
    s_cmp_ge_u32 s66, 2
    s_cbranch_scc1 L_noprod
    v_lshrrev_b32 v3, 4, v0
    v_and_b32 v4, 7, v0
    v_lshlrev_b32 v5, 10, v4
    v_lshl_add_u32 v5, v3, 4, v5
    s_lshl_b32 s72, s65, 8
    v_lshrrev_b32 v6, 3, v0
    v_lshlrev_b32 v6, 13, v6
    v_and_b32 v7, 1, v3
    v_lshlrev_b32 v7, 1, v7
    v_xor_b32 v7, v7, v4
    v_lshl_add_u32 v6, v7, 4, v6
    v_xor_b32 v7, 64, v6
    s_lshr_b32 s70, s62, 2
    s_lshl_b32 s73, s65, 20
    s_lshl_b32 s4, s63, 8
    s_add_u32 s73, s73, s4
    s_lshl_b32 s4, s70, 7
    s_add_u32 s73, s73, s4
    s_lshl_b32 s74, s66, 14
    s_add_u32 s74, s74, 16384
    s_mov_b32 m0, s74
    s_mov_b32 s10, 0x400000
    s_mov_b32 s14, 0x2000
    s_cmp_eq_u32 s66, 0
    s_cbranch_scc1 L_prio_b
    s_setprio 2
L_prio_b:
    s_waitcnt lgkmcnt(0)
    s_cselect_b32 s12, s46, s36
    s_cselect_b32 s13, s47, s37
    s_cselect_b32 s8, s52, s42
    s_cselect_b32 s9, s53, s43
    s_and_b32 s13, s13, 0xffff
    s_and_b32 s9, s9, 0xffff
    buffer_load_dwordx4 v[16:19], v5, s[12:15], s72 offen offset:0
    buffer_load_dwordx4 v[20:23], v5, s[12:15], s72 offen offset:64
    buffer_load_dwordx4 v[24:27], v5, s[12:15], s72 offen offset:128
    buffer_load_dwordx4 v[28:31], v5, s[12:15], s72 offen offset:192
    buffer_load_dwordx4 v6, s[8:11], s73 offen nt lds
    s_add_u32 m0, m0, 0x400
    s_add_u32 s73, s73, 65536
    buffer_load_dwordx4 v7, s[8:11], s73 offen nt lds
    s_add_u32 m0, m0, 0x400
    s_add_u32 s73, s73, 65536
    buffer_load_dwordx4 v6, s[8:11], s73 offen nt lds
    s_add_u32 m0, m0, 0x400
    s_add_u32 s73, s73, 65536
    buffer_load_dwordx4 v7, s[8:11], s73 offen nt lds
    s_add_u32 m0, m0, 0x400
    s_add_u32 s73, s73, 65536
    buffer_load_dwordx4 v6, s[8:11], s73 offen nt lds
    s_add_u32 m0, m0, 0x400
    s_add_u32 s73, s73, 65536
    buffer_load_dwordx4 v7, s[8:11], s73 offen nt lds
    s_add_u32 m0, m0, 0x400
    s_add_u32 s73, s73, 65536
    buffer_load_dwordx4 v6, s[8:11], s73 offen nt lds
    s_add_u32 m0, m0, 0x400
    s_add_u32 s73, s73, 65536
    buffer_load_dwordx4 v7, s[8:11], s73 offen nt lds
    s_add_u32 m0, m0, 0x400
    s_add_u32 s73, s73, 65536
    buffer_load_dwordx4 v6, s[8:11], s73 offen nt lds
    s_add_u32 m0, m0, 0x400
    s_add_u32 s73, s73, 65536
    buffer_load_dwordx4 v7, s[8:11], s73 offen nt lds
    s_add_u32 m0, m0, 0x400
    s_add_u32 s73, s73, 65536
    buffer_load_dwordx4 v6, s[8:11], s73 offen nt lds
    s_add_u32 m0, m0, 0x400
    s_add_u32 s73, s73, 65536
    buffer_load_dwordx4 v7, s[8:11], s73 offen nt lds
    s_add_u32 m0, m0, 0x400
    s_add_u32 s73, s73, 65536
    buffer_load_dwordx4 v6, s[8:11], s73 offen nt lds
    s_add_u32 m0, m0, 0x400
    s_add_u32 s73, s73, 65536
    buffer_load_dwordx4 v7, s[8:11], s73 offen nt lds
    s_add_u32 m0, m0, 0x400
    s_add_u32 s73, s73, 65536
    buffer_load_dwordx4 v6, s[8:11], s73 offen nt lds
    s_add_u32 m0, m0, 0x400
    s_add_u32 s73, s73, 65536
    buffer_load_dwordx4 v7, s[8:11], s73 offen nt lds
    s_mov_b32 s29, 0xffffff00
    s_mov_b32 s30, 0x0c0c0400
    s_mov_b32 s31, 0x04000c0c
    v_mov_b32 v2, 0
    s_bfe_u32 s67, s63, 0x10003
    s_lshr_b32 s4, s62, 2
    s_lshl1_add_u32 s67, s4, s67
    s_lshr_b32 s4, s63, 4
    s_lshl2_add_u32 s67, s4, s67
    s_and_b32 s68, s63, 4
    s_or_b32 s68, s68, s65
    s_and_b32 s69, s63, 3
    s_mov_b32 s77, 0x3e0293ee
    s_mov_b32 s82, 0x400000
    s_mov_b32 s24, s60
    s_and_b32 s25, s61, 0xffff
    s_mov_b32 s26, 0xa00000
    s_mov_b32 s27, 0x20000
    s_barrier
    v_bfe_u32 v4, v0, 2, 2
    v_and_b32 v5, 3, v0
    v_lshl_add_u32 v6, v3, 3, v4
    v_lshlrev_b32 v6, 7, v6
    v_lshl_add_u32 v6, v5, 3, v6
    v_lshrrev_b32 v4, 1, v4
    v_and_b32 v5, 1, v3
    v_lshl_add_u32 v4, v5, 1, v4
    v_lshl_add_u32 v6, v4, 5, v6
    v_add_u32 v8, s74, v6
    v_xor_b32 v9, 32, v8
    v_xor_b32 v10, 64, v8
    v_xor_b32 v11, 96, v8
    v_and_b32 v4, 7, v0
    v_lshlrev_b32 v4, 4, v4
    v_bfe_i32 v5, v0, 3, 1
    v_and_b32 v5, 0x80, v5
    v_xor_b32 v4, v4, v5
    v_bfe_i32 v5, v0, 5, 1
    v_and_b32 v5, 0x20000, v5
    v_xor_b32 v4, v4, v5
    v_bfe_i32 v5, v0, 4, 1
    v_and_b32 v5, 0x40000, v5
    v_xor_b32 v4, v4, v5
    s_lshl_b32 s5, s2, 8
    s_xor_b32 s5, s5, 0x180000
    s_bitcmp1_b32 s66, 0
    s_cselect_b32 s4, 0x80000, 0
    s_xor_b32 s5, s5, s4
    v_xor_b32 v4, s5, v4
    v_xor_b32 v5, 0x10000, v4
    s_mov_b32 s72, 6291456
    s_mov_b32 s32, 0
    s_mov_b32 s33, -1
    s_waitcnt vmcnt(12)
    ds_read_b64_tr_b16 v[64:65], v8 offset:0
    ds_read_b64_tr_b16 v[66:67], v8 offset:512
    ds_read_b64_tr_b16 v[68:69], v9 offset:0
    ds_read_b64_tr_b16 v[70:71], v9 offset:512
    ds_read_b64_tr_b16 v[72:73], v10 offset:0
    ds_read_b64_tr_b16 v[74:75], v10 offset:512
    ds_read_b64_tr_b16 v[76:77], v11 offset:0
    ds_read_b64_tr_b16 v[78:79], v11 offset:512
    s_waitcnt lgkmcnt(0)
    v_mfma_f32_16x16x32_bf16 v[32:35], v[16:19], v[64:67], 0
    v_mfma_f32_16x16x32_bf16 v[36:39], v[16:19], v[68:71], 0
    v_mfma_f32_16x16x32_bf16 v[40:43], v[16:19], v[72:75], 0
    v_mfma_f32_16x16x32_bf16 v[44:47], v[16:19], v[76:79], 0
    s_waitcnt vmcnt(8)
    ds_read_b64_tr_b16 v[80:81], v8 offset:4096
    ds_read_b64_tr_b16 v[82:83], v8 offset:4608
    ds_read_b64_tr_b16 v[84:85], v9 offset:4096
    ds_read_b64_tr_b16 v[86:87], v9 offset:4608
    ds_read_b64_tr_b16 v[88:89], v10 offset:4096
    ds_read_b64_tr_b16 v[90:91], v10 offset:4608
    ds_read_b64_tr_b16 v[92:93], v11 offset:4096
    ds_read_b64_tr_b16 v[94:95], v11 offset:4608
    s_waitcnt lgkmcnt(0)
    v_mfma_f32_16x16x32_bf16 v[32:35], v[20:23], v[80:83], v[32:35]
    v_mfma_f32_16x16x32_bf16 v[36:39], v[20:23], v[84:87], v[36:39]
    v_mfma_f32_16x16x32_bf16 v[40:43], v[20:23], v[88:91], v[40:43]
    v_mfma_f32_16x16x32_bf16 v[44:47], v[20:23], v[92:95], v[44:47]
    s_waitcnt vmcnt(4)
    ds_read_b64_tr_b16 v[96:97], v8 offset:8192
    ds_read_b64_tr_b16 v[98:99], v8 offset:8704
    ds_read_b64_tr_b16 v[100:101], v9 offset:8192
    ds_read_b64_tr_b16 v[102:103], v9 offset:8704
    ds_read_b64_tr_b16 v[104:105], v10 offset:8192
    ds_read_b64_tr_b16 v[106:107], v10 offset:8704
    ds_read_b64_tr_b16 v[108:109], v11 offset:8192
    ds_read_b64_tr_b16 v[110:111], v11 offset:8704
    s_waitcnt lgkmcnt(0)
    v_mfma_f32_16x16x32_bf16 v[32:35], v[24:27], v[96:99], v[32:35]
    v_mfma_f32_16x16x32_bf16 v[36:39], v[24:27], v[100:103], v[36:39]
    v_mfma_f32_16x16x32_bf16 v[40:43], v[24:27], v[104:107], v[40:43]
    v_mfma_f32_16x16x32_bf16 v[44:47], v[24:27], v[108:111], v[44:47]
    s_waitcnt vmcnt(0)
    ds_read_b64_tr_b16 v[112:113], v8 offset:12288
    ds_read_b64_tr_b16 v[114:115], v8 offset:12800
    ds_read_b64_tr_b16 v[116:117], v9 offset:12288
    ds_read_b64_tr_b16 v[118:119], v9 offset:12800
    ds_read_b64_tr_b16 v[120:121], v10 offset:12288
    ds_read_b64_tr_b16 v[122:123], v10 offset:12800
    ds_read_b64_tr_b16 v[124:125], v11 offset:12288
    ds_read_b64_tr_b16 v[126:127], v11 offset:12800
    s_waitcnt lgkmcnt(0)
    v_mfma_f32_16x16x32_bf16 v[32:35], v[28:31], v[112:115], v[32:35]
    v_mfma_f32_16x16x32_bf16 v[36:39], v[28:31], v[116:119], v[36:39]
    v_mfma_f32_16x16x32_bf16 v[40:43], v[28:31], v[120:123], v[40:43]
    v_mfma_f32_16x16x32_bf16 v[44:47], v[28:31], v[124:127], v[44:47]
    v_mov_b32 v6, 32
L_sp_107:
    ds_read_b32 v7, v6
    s_waitcnt lgkmcnt(0)
    v_readfirstlane_b32 s28, v7
    s_nop 0
    s_cmp_lg_u32 s28, 0
    s_cbranch_scc1 L_ok_108
    s_sub_u32 s82, s82, 1
    s_cmp_lg_u32 s82, 0
    s_cbranch_scc1 L_sp_107
    s_endpgm
L_ok_108:
    s_bfe_u32 s4, s28, 0x80000
    v_mov_b32 v12, s4
    s_bfe_u32 s4, s28, 0x80008
    v_mov_b32 v13, s4
    s_bfe_u32 s4, s28, 0x80010
    v_mov_b32 v14, s4
    s_bfe_u32 s4, s28, 0x80018
    v_mov_b32 v15, s4
    v_cndmask_b32 v48, v32, v34, s[32:33]
    v_cndmask_b32 v49, v36, v38, s[32:33]
    v_cndmask_b32 v50, v40, v42, s[32:33]
    v_cndmask_b32 v51, v44, v46, s[32:33]
    v_cndmask_b32 v52, v33, v35, s[32:33]
    v_cndmask_b32 v53, v37, v39, s[32:33]
    v_cndmask_b32 v54, v41, v43, s[32:33]
    v_cndmask_b32 v55, v45, v47, s[32:33]
    v_and_or_b32 v48, v48, s29, v12
    v_and_or_b32 v49, v49, s29, v13
    v_and_or_b32 v50, v50, s29, v14
    v_and_or_b32 v51, v51, s29, v15
    v_and_or_b32 v52, v52, s29, v12
    v_and_or_b32 v53, v53, s29, v13
    v_and_or_b32 v54, v54, s29, v14
    v_and_or_b32 v55, v55, s29, v15
    buffer_store_dwordx4 v[48:51], v4, s[24:27], s72 offen sc1
    buffer_store_dwordx4 v[52:55], v5, s[24:27], s72 offen sc1
    s_cmp_lg_u32 s66, 0
    s_cbranch_scc1 L_h_b3
    v_and_b32 v8, 7, v0
    v_lshlrev_b32 v8, 4, v8
    v_bfe_i32 v7, v0, 3, 1
    v_and_b32 v7, 0x80, v7
    v_xor_b32 v8, v8, v7
    v_bfe_i32 v7, v0, 4, 1
    v_and_b32 v7, 0x400, v7
    v_xor_b32 v8, v8, v7
    v_bfe_i32 v7, v0, 5, 1
    v_and_b32 v7, 0x100, v7
    v_xor_b32 v8, v8, v7
    v_and_b32 v6, 15, v0
    v_lshlrev_b32 v6, 1, v6
    v_bfe_i32 v7, v0, 4, 1
    v_and_b32 v7, 0x80, v7
    v_xor_b32 v6, v6, v7
    v_bfe_i32 v7, v0, 5, 1
    v_and_b32 v7, 0x40, v7
    v_xor_b32 v6, v6, v7
    s_lshl_b32 s5, s63, 11
    s_xor_b32 s5, s5, 0x180000
    s_bitcmp1_b32 s62, 0
    s_cselect_b32 s4, 0x10000, 0
    s_xor_b32 s5, s5, s4
    s_bitcmp1_b32 s62, 1
    s_cselect_b32 s4, 0x20000, 0
    s_xor_b32 s5, s5, s4
    s_bitcmp1_b32 s62, 2
    s_cselect_b32 s4, 0x40000, 0
    s_xor_b32 s5, s5, s4
    v_xor_b32 v8, s5, v8
    v_xor_b32 v9, 0x200, v8
    s_sleep 24
    buffer_load_dwordx4 v[64:67], v8, s[24:27], s72 offen sc1
    buffer_load_dwordx4 v[68:71], v9, s[24:27], s72 offen sc1
L_qp_loop:
    s_waitcnt vmcnt(0)
    v_perm_b32 v20, v65, v64, s30
    v_perm_b32 v21, v67, v66, s31
    v_or_b32 v20, v20, v21
    v_xor_b32 v22, s28, v20
    v_perm_b32 v20, v69, v68, s30
    v_perm_b32 v21, v71, v70, s31
    v_or_b32 v20, v20, v21
    v_xor_b32 v20, s28, v20
    v_or_b32 v22, v22, v20
    v_cmp_ne_u32 vcc, 0, v22
    s_cbranch_vccz L_qp_ok0
    buffer_load_dwordx4 v[64:67], v8, s[24:27], s72 offen sc1
    buffer_load_dwordx4 v[68:71], v9, s[24:27], s72 offen sc1
    s_sub_u32 s82, s82, 1
    s_cmp_lg_u32 s82, 0
    s_cbranch_scc1 L_qp_loop
    s_endpgm
L_qp_ok0:
    v_and_b32 v64, s29, v64
    v_and_b32 v65, s29, v65
    v_and_b32 v66, s29, v66
    v_and_b32 v67, s29, v67
    v_and_b32 v68, s29, v68
    v_and_b32 v69, s29, v69
    v_and_b32 v70, s29, v70
    v_and_b32 v71, s29, v71
    v_add_f32 v64, v64, v68
    v_add_f32 v65, v65, v69
    v_add_f32 v66, v66, v70
    v_add_f32 v67, v67, v71
    s_nop 1
    v_permlane32_swap_b32 v64, v66
    v_permlane32_swap_b32 v65, v67
    s_nop 0
    v_add_f32 v64, v64, v66
    v_add_f32 v65, v65, v67
    v_cvt_pk_bf16_f32 v64, v64, v65
    ds_write_b16 v6, v64 offset:1024
    ds_write_b16_d16_hi v6, v64 offset:1056
L_qp_ok:
    v_mov_b32 v20, 0
    v_mov_b32 v21, 1
    s_mov_b64 exec, 1
    ds_write_b32 v20, v21
    s_mov_b64 exec, -1
    v_and_b32 v6, 7, v0
    v_lshlrev_b32 v6, 4, v6
    v_bfe_i32 v7, v0, 3, 1
    v_and_b32 v7, 0x80, v7
    v_xor_b32 v6, v6, v7
    v_bfe_i32 v7, v0, 4, 1
    v_and_b32 v7, 0x100, v7
    v_xor_b32 v6, v6, v7
    v_bfe_i32 v7, v0, 5, 1
    v_and_b32 v7, 0x200, v7
    v_xor_b32 v6, v6, v7
    v_bfe_u32 v8, v0, 2, 2
    v_lshlrev_b32 v8, 4, v8
    s_lshl3_add_u32 s73, s68, s67
    s_lshl2_add_u32 s4, s73, s69
    s_lshl_b32 s4, s4, 12
    s_xor_b32 s5, s4, 0x800
    v_xor_b32 v7, s5, v6
    s_xor_b32 s5, s4, 0x400
    v_xor_b32 v6, s5, v6
    s_xor_b32 s5, s4, 0xc00
    v_xor_b32 v8, s5, v8
    v_lshrrev_b32 v11, 4, v0
    v_lshlrev_b32 v11, 12, v11
    v_and_b32 v9, 3, v0
    v_lshl_add_u32 v9, v9, 4, v11
    v_bfe_i32 v10, v0, 2, 1
    v_and_b32 v10, 0x100, v10
    v_xor_b32 v9, v9, v10
    v_bfe_i32 v10, v0, 3, 1
    v_and_b32 v10, 0x200, v10
    v_xor_b32 v9, v9, v10
    s_lshl_b32 s73, s73, 14
    s_lshl_b32 s5, s69, 4
    s_xor_b32 s5, s5, s73
    s_xor_b32 s5, s5, 0xc00
    v_xor_b32 v11, s5, v11
    s_bitcmp1_b32 s69, 0
    s_cselect_b32 s4, 0x40, 0
    s_xor_b32 s73, s73, s4
    s_bitcmp1_b32 s69, 1
    s_cselect_b32 s4, 0x80, 0
    s_xor_b32 s73, s73, s4
    s_xor_b32 s5, s73, 0x800
    v_xor_b32 v10, s5, v9
    s_xor_b32 s5, s73, 0x400
    v_xor_b32 v9, s5, v9
    s_mov_b32 s72, 3145728
    v_mov_b32 v20, 36
L_sp_109:
    ds_read_b32 v21, v20
    s_waitcnt lgkmcnt(0)
    v_readfirstlane_b32 s4, v21
    s_nop 0
    s_cmp_eq_u32 s4, 4
    s_cbranch_scc1 L_ok_110
    s_sleep 8
    s_sub_u32 s82, s82, 1
    s_cmp_lg_u32 s82, 0
    s_cbranch_scc1 L_sp_109
    s_endpgm
L_ok_110:
    ds_read_b32 v20, v2 offset:20
    s_waitcnt lgkmcnt(0)
    v_readfirstlane_b32 s75, v20
    s_lshl3_add_u32 s5, s68, s67
    s_mul_i32 s5, s5, 0
    s_add_u32 s5, s5, 456
    v_mov_b32 v20, 4
L_sp_111:
    ds_read_b32 v21, v20
    s_waitcnt lgkmcnt(0)
    v_readfirstlane_b32 s4, v21
    s_nop 0
    s_cmp_ge_u32 s4, s5
    s_cbranch_scc1 L_ok_112
    s_sleep 16
    s_sub_u32 s82, s82, 1
    s_cmp_lg_u32 s82, 0
    s_cbranch_scc1 L_sp_111
    s_endpgm
L_ok_112:
    v_lshlrev_b32 v176, 4, v0
    v_lshlrev_b32 v177, 3, v0
    ds_read_b64 v[136:137], v177 offset:6144
    ds_read_b64 v[148:149], v177 offset:9216
    ds_read_b64 v[160:161], v177 offset:12288
    ds_read_b64 v[172:173], v177 offset:15360
    ds_read_b128 v[128:131], v176 offset:4096
    ds_read_b128 v[132:135], v176 offset:5120
    ds_read_b128 v[140:143], v176 offset:7168
    ds_read_b128 v[144:147], v176 offset:8192
    ds_read_b128 v[152:155], v176 offset:10240
    ds_read_b128 v[156:159], v176 offset:11264
    ds_read_b128 v[164:167], v176 offset:13312
    ds_read_b128 v[168:171], v176 offset:14336
    s_waitcnt lgkmcnt(8)
    v_max3_f32 v178, v136, v148, v160
    v_max_f32 v178, v178, v172
    v_sub_f32 v136, v136, v178
    v_sub_f32 v148, v148, v178
    v_sub_f32 v160, v160, v178
    v_sub_f32 v172, v172, v178
    v_exp_f32 v136, v136
    v_exp_f32 v148, v148
    v_exp_f32 v160, v160
    v_exp_f32 v172, v172
    v_mul_f32 v179, v136, v137
    v_fmac_f32 v179, v148, v149
    v_fmac_f32 v179, v160, v161
    v_fmac_f32 v179, v172, v173
    v_mov_b32 v176, v179
    s_waitcnt lgkmcnt(6)
    v_mul_f32 v128, v136, v128
    v_mul_f32 v129, v136, v129
    v_mul_f32 v130, v136, v130
    v_mul_f32 v131, v136, v131
    v_mul_f32 v132, v136, v132
    v_mul_f32 v133, v136, v133
    v_mul_f32 v134, v136, v134
    v_mul_f32 v135, v136, v135
    v_permlane32_swap_b32 v176, v179
    s_waitcnt lgkmcnt(4)
    v_add_f32 v179, v179, v176
    v_mov_b32 v176, v179
    v_fmac_f32 v128, v148, v140
    v_fmac_f32 v129, v148, v141
    v_fmac_f32 v130, v148, v142
    v_fmac_f32 v131, v148, v143
    v_fmac_f32 v132, v148, v144
    v_fmac_f32 v133, v148, v145
    v_fmac_f32 v134, v148, v146
    v_fmac_f32 v135, v148, v147
    v_permlane16_swap_b32 v176, v179
    s_waitcnt lgkmcnt(2)
    v_add_f32 v179, v179, v176
    v_fmac_f32 v128, v160, v152
    v_fmac_f32 v129, v160, v153
    v_fmac_f32 v130, v160, v154
    v_fmac_f32 v131, v160, v155
    v_fmac_f32 v132, v160, v156
    v_fmac_f32 v133, v160, v157
    v_fmac_f32 v134, v160, v158
    v_fmac_f32 v135, v160, v159
    s_waitcnt lgkmcnt(0)
    v_fmac_f32 v128, v172, v164
    v_fmac_f32 v129, v172, v165
    v_fmac_f32 v130, v172, v166
    v_fmac_f32 v131, v172, v167
    v_fmac_f32 v132, v172, v168
    v_fmac_f32 v133, v172, v169
    v_fmac_f32 v134, v172, v170
    v_fmac_f32 v135, v172, v171
    s_cmp_eq_u32 s75, 0
    s_cbranch_scc1 L_far_113
    buffer_store_dwordx4 v[128:131], v6, s[24:27], s72 offen
    buffer_store_dwordx4 v[132:135], v7, s[24:27], s72 offen
L_sent_114:
    v_mov_b32 v180, s28
    s_mov_b64 exec, 0x1111
    s_waitcnt vmcnt(0)
    s_cmp_eq_u32 s75, 0
    s_cbranch_scc1 L_far_115
    buffer_store_dwordx3 v[178:180], v8, s[24:27], s72 offen
L_sent_116:
    s_mov_b64 exec, -1
    v_mov_b32 v20, 4
L_sp_117:
    ds_read_b32 v21, v20
    s_waitcnt lgkmcnt(0)
    v_readfirstlane_b32 s4, v21
    s_nop 0
    s_cmp_ge_u32 s4, 468
    s_cbranch_scc1 L_ok_118
    s_sleep 16
    s_sub_u32 s82, s82, 1
    s_cmp_lg_u32 s82, 0
    s_cbranch_scc1 L_sp_117
    s_endpgm
L_ok_118:
L_mg:
    buffer_load_dwordx3 v[32:34], v11, s[24:27], s72 offen sc1
    s_waitcnt vmcnt(0)
    v_cmp_ne_u32 vcc, s28, v34
    s_cbranch_vccz L_mg_ok
    s_sleep 16
    s_sub_u32 s82, s82, 1
    s_cmp_lg_u32 s82, 0
    s_cbranch_scc1 L_mg
    s_endpgm
L_mg_ok:
    buffer_load_dwordx4 v[36:39], v9, s[24:27], s72 offen sc1
    buffer_load_dwordx4 v[40:43], v10, s[24:27], s72 offen sc1
    v_mov_b32 v34, v32
    v_mov_b32 v35, v34
    s_nop 1
    v_permlane16_swap_b32 v35, v34
    s_nop 0
    v_max_f32 v34, v34, v35
    v_mov_b32 v35, v34
    s_nop 1
    v_permlane32_swap_b32 v35, v34
    s_nop 0
    v_max_f32 v34, v34, v35
    v_sub_f32 v32, v32, v34
    v_exp_f32 v32, v32
    s_nop 0
    v_mul_f32 v33, v33, v32
    v_mov_b32 v35, v33
    s_nop 1
    v_permlane16_swap_b32 v35, v33
    s_nop 0
    v_add_f32 v33, v33, v35
    v_mov_b32 v35, v33
    s_nop 1
    v_permlane32_swap_b32 v35, v33
    s_nop 0
    v_add_f32 v33, v33, v35
    v_rcp_f32 v33, v33
    s_nop 0
    v_mul_f32 v32, v32, v33
    s_waitcnt vmcnt(0)
    v_mul_f32 v36, v36, v32
    v_mul_f32 v37, v37, v32
    v_mul_f32 v38, v38, v32
    v_mul_f32 v39, v39, v32
    v_mul_f32 v40, v40, v32
    v_mul_f32 v41, v41, v32
    v_mul_f32 v42, v42, v32
    v_mul_f32 v43, v43, v32
    v_mov_b32 v35, v36
    s_nop 1
    v_permlane16_swap_b32 v35, v36
    s_nop 0
    v_add_f32 v36, v36, v35
    v_mov_b32 v35, v36
    s_nop 1
    v_permlane32_swap_b32 v35, v36
    s_nop 0
    v_add_f32 v36, v36, v35
    v_mov_b32 v35, v37
    s_nop 1
    v_permlane16_swap_b32 v35, v37
    s_nop 0
    v_add_f32 v37, v37, v35
    v_mov_b32 v35, v37
    s_nop 1
    v_permlane32_swap_b32 v35, v37
    s_nop 0
    v_add_f32 v37, v37, v35
    v_mov_b32 v35, v38
    s_nop 1
    v_permlane16_swap_b32 v35, v38
    s_nop 0
    v_add_f32 v38, v38, v35
    v_mov_b32 v35, v38
    s_nop 1
    v_permlane32_swap_b32 v35, v38
    s_nop 0
    v_add_f32 v38, v38, v35
    v_mov_b32 v35, v39
    s_nop 1
    v_permlane16_swap_b32 v35, v39
    s_nop 0
    v_add_f32 v39, v39, v35
    v_mov_b32 v35, v39
    s_nop 1
    v_permlane32_swap_b32 v35, v39
    s_nop 0
    v_add_f32 v39, v39, v35
    v_mov_b32 v35, v40
    s_nop 1
    v_permlane16_swap_b32 v35, v40
    s_nop 0
    v_add_f32 v40, v40, v35
    v_mov_b32 v35, v40
    s_nop 1
    v_permlane32_swap_b32 v35, v40
    s_nop 0
    v_add_f32 v40, v40, v35
    v_mov_b32 v35, v41
    s_nop 1
    v_permlane16_swap_b32 v35, v41
    s_nop 0
    v_add_f32 v41, v41, v35
    v_mov_b32 v35, v41
    s_nop 1
    v_permlane32_swap_b32 v35, v41
    s_nop 0
    v_add_f32 v41, v41, v35
    v_mov_b32 v35, v42
    s_nop 1
    v_permlane16_swap_b32 v35, v42
    s_nop 0
    v_add_f32 v42, v42, v35
    v_mov_b32 v35, v42
    s_nop 1
    v_permlane32_swap_b32 v35, v42
    s_nop 0
    v_add_f32 v42, v42, v35
    v_mov_b32 v35, v43
    s_nop 1
    v_permlane16_swap_b32 v35, v43
    s_nop 0
    v_add_f32 v43, v43, v35
    v_mov_b32 v35, v43
    s_nop 1
    v_permlane32_swap_b32 v35, v43
    s_nop 0
    v_add_f32 v43, v43, v35
    v_cvt_pk_bf16_f32 v36, v36, v37
    v_cvt_pk_bf16_f32 v37, v38, v39
    v_cvt_pk_bf16_f32 v38, v40, v41
    v_cvt_pk_bf16_f32 v39, v42, v43
    v_min_u32 v36, -2, v36
    v_min_u32 v37, -2, v37
    v_min_u32 v38, -2, v38
    v_min_u32 v39, -2, v39
    v_mov_b32 v140, v36
    v_mov_b32 v141, v37
    v_mov_b32 v142, v38
    v_mov_b32 v143, v39
    s_branch L_h_b3
L_noprod:
    s_memrealtime s[84:85]
    s_mov_b32 s29, 0xffffff00
    s_mov_b32 s30, 0x0c0c0400
    s_mov_b32 s31, 0x04000c0c
    v_mov_b32 v2, 0
    s_waitcnt lgkmcnt(0)
    s_bfe_u32 s67, s63, 0x10003
    s_lshr_b32 s4, s62, 2
    s_lshl1_add_u32 s67, s4, s67
    s_lshr_b32 s4, s63, 4
    s_lshl2_add_u32 s67, s4, s67
    s_and_b32 s68, s63, 4
    s_or_b32 s68, s68, s65
    s_and_b32 s69, s63, 3
    s_mov_b32 s77, 0x3e0293ee
    s_mov_b32 s82, 0x400000
    s_mov_b32 s24, s60
    s_and_b32 s25, s61, 0xffff
    s_mov_b32 s26, 0xa00000
    s_mov_b32 s27, 0x20000
    s_cmp_lg_u32 s66, 2
    s_cbranch_scc1 L_w7
    s_mul_i32 s28, s84, 0x9e3779b1
    s_or_b32 s28, s28, 1
    v_lshlrev_b32 v20, 7, v0
    v_mov_b32 v21, s28
    s_cmp_lg_u32 s2, 0
    s_cbranch_scc1 L_notag
    s_mov_b64 exec, 3
    global_store_dword v20, v21, s[58:59] sc1
    s_mov_b64 exec, -1
L_notag:
    v_and_b32 v26, 7, v0
    v_lshlrev_b32 v26, 4, v26
    v_bfe_i32 v27, v0, 3, 1
    v_and_b32 v27, 0x8180, v27
    v_xor_b32 v26, v26, v27
    v_bfe_i32 v27, v0, 4, 1
    v_and_b32 v27, 0x10200, v27
    v_xor_b32 v26, v26, v27
    v_bfe_i32 v27, v0, 5, 1
    v_and_b32 v27, 0x20400, v27
    v_xor_b32 v26, v26, v27
    s_lshl_b32 s5, s2, 7
    v_xor_b32 v26, s5, v26
    s_mov_b32 s80, 8388608
    v_mov_b32 v28, -1
    v_mov_b32 v29, -1
    v_mov_b32 v30, -1
    v_mov_b32 v31, -1
    s_mov_b32 exec_hi, 0
    buffer_store_dwordx4 v[28:31], v26, s[24:27], s80 offen sc1
    s_mov_b64 exec, -1
    s_barrier
    s_cmp_eq_u32 s2, 0
    s_cbranch_scc1 L_tag_ok
    s_and_b32 s4, s63, 1
    s_lshl_b32 s4, s4, 7
    v_mov_b32 v20, s4
    s_mov_b64 exec, 1
    s_sleep 2
L_tag:
    global_load_dword v21, v20, s[58:59] sc1
    s_waitcnt vmcnt(0)
    v_readfirstlane_b32 s28, v21
    s_nop 0
    s_cmp_lg_u32 s28, 0
    s_cbranch_scc1 L_tag_ok
    s_sleep 4
    s_sub_u32 s82, s82, 1
    s_cmp_lg_u32 s82, 0
    s_cbranch_scc1 L_tag
    s_endpgm
L_tag_ok:
    s_waitcnt vmcnt(0)
    v_mov_b32 v20, 32
    v_mov_b32 v21, s28
    s_mov_b64 exec, 1
    ds_write_b32 v20, v21
    s_mov_b64 exec, -1
    s_branch L_gather
L_w7:
    v_lshlrev_b32 v1, 4, v0
    v_mov_b32 v3, 0
    v_mov_b32 v4, 0
    v_mov_b32 v5, 0
    ds_write_b128 v1, v[2:5]
    s_waitcnt lgkmcnt(0)
    s_barrier
    s_cmp_ge_u32 s63, 2
    s_cbranch_scc1 L_nopf
    s_getpc_b64 s[4:5]
L_pc:
    s_sub_u32 s4, s4, L_pc-concat_heads__sliding_block_cached__mha_block_cached__decode_kernel
    s_subb_u32 s5, s5, 0
    s_lshl_b32 s6, s63, 13
    v_lshlrev_b32 v3, 7, v0
    v_mov_b32 v5, s5
    v_add_u32 v3, s6, v3
    v_min_u32 v3, L_code_end-concat_heads__sliding_block_cached__mha_block_cached__decode_kernel-4, v3
    v_add_co_u32 v4, vcc, s4, v3
    s_nop 1
    v_addc_co_u32 v5, vcc, 0, v5, vcc
    global_load_dword v10, v[4:5], off
L_nopf:
    v_mov_b32 v6, 32
L_sp_119:
    ds_read_b32 v7, v6
    s_waitcnt lgkmcnt(0)
    v_readfirstlane_b32 s28, v7
    s_nop 0
    s_cmp_lg_u32 s28, 0
    s_cbranch_scc1 L_ok_120
    s_sleep 4
    s_sub_u32 s82, s82, 1
    s_cmp_lg_u32 s82, 0
    s_cbranch_scc1 L_sp_119
    s_endpgm
L_ok_120:
    s_getreg_b32 s4, hwreg(HW_REG_XCC_ID)
    s_and_b32 s4, s4, 15
    s_lshl_b32 s4, s4, 1
    s_xor_b32 s75, s28, s4
    s_lshl_b32 s72, s62, 7
    s_add_u32 s72, s72, 2621440
    s_lshl_b32 s4, s63, 2
    v_mov_b32 v24, s4
    v_mov_b32 v25, s75
    s_mov_b64 exec, 1
    buffer_store_dword v25, v24, s[24:27], s72 offen
    s_mov_b64 exec, -1
    v_and_b32 v24, 31, v0
    v_lshlrev_b32 v24, 2, v24
    v_mov_b32 v20, 4
L_sp_121:
    ds_read_b32 v21, v20
    s_waitcnt lgkmcnt(0)
    v_readfirstlane_b32 s4, v21
    s_nop 0
    s_cmp_ge_u32 s4, 24
    s_cbranch_scc1 L_ok_122
    s_sleep 16
    s_sub_u32 s82, s82, 1
    s_cmp_lg_u32 s82, 0
    s_cbranch_scc1 L_sp_121
    s_endpgm
L_ok_122:
    buffer_load_dword v25, v24, s[24:27], s72 offen sc1
    s_waitcnt vmcnt(0)
    v_cmp_ne_u32 vcc, s75, v25
    s_cbranch_vccnz L_h_b3
    v_mov_b32 v20, 20
    v_mov_b32 v21, 1
    s_mov_b64 exec, 1
    ds_write_b32 v20, v21
    s_mov_b64 exec, -1
    s_branch L_h_b3
L_gather:
    v_and_b32 v24, 7, v0
    v_lshlrev_b32 v24, 4, v24
    v_bfe_i32 v7, v0, 3, 1
    v_and_b32 v7, 0x80, v7
    v_xor_b32 v24, v24, v7
    v_bfe_i32 v7, v0, 4, 1
    v_and_b32 v7, 0x400, v7
    v_xor_b32 v24, v24, v7
    v_bfe_i32 v7, v0, 5, 1
    v_and_b32 v7, 0x100, v7
    v_xor_b32 v24, v24, v7
    v_and_b32 v6, 15, v0
    v_lshlrev_b32 v6, 1, v6
    v_bfe_i32 v7, v0, 4, 1
    v_and_b32 v7, 0x80, v7
    v_xor_b32 v6, v6, v7
    v_bfe_i32 v7, v0, 5, 1
    v_and_b32 v7, 0x40, v7
    v_xor_b32 v6, v6, v7
    s_lshl_b32 s5, s68, 13
    s_xor_b32 s5, s5, 0x100000
    s_mov_b32 s72, 6291456
    s_bitcmp1_b32 s67, 0
    s_cselect_b32 s4, 0x10000, 0
    s_xor_b32 s5, s5, s4
    s_bitcmp1_b32 s67, 1
    s_cselect_b32 s4, 0x20000, 0
    s_xor_b32 s5, s5, s4
    s_bitcmp1_b32 s67, 2
    s_cselect_b32 s4, 0x40000, 0
    s_xor_b32 s5, s5, s4
    v_xor_b32 v24, s5, v24
    v_xor_b32 v25, 0x200, v24
    v_xor_b32 v26, 0x800, v24
    v_xor_b32 v27, 0xa00, v24
    v_xor_b32 v28, 0x1000, v24
    v_xor_b32 v29, 0x1200, v24
    v_xor_b32 v30, 0x1800, v24
    v_xor_b32 v31, 0x1a00, v24
    v_mov_b32 v20, 0
L_sp_123:
    ds_read_b32 v21, v20
    s_waitcnt lgkmcnt(0)
    v_readfirstlane_b32 s4, v21
    s_nop 0
    s_cmp_lg_u32 s4, 0
    s_cbranch_scc1 L_ok_124
    s_sleep 4
    s_sub_u32 s82, s82, 1
    s_cmp_lg_u32 s82, 0
    s_cbranch_scc1 L_sp_123
    s_endpgm
L_ok_124:
L_g_loop:
    buffer_load_dwordx4 v[64:67], v24, s[24:27], s72 offen sc1
    buffer_load_dwordx4 v[68:71], v25, s[24:27], s72 offen sc1
    buffer_load_dwordx4 v[72:75], v26, s[24:27], s72 offen sc1
    buffer_load_dwordx4 v[76:79], v27, s[24:27], s72 offen sc1
    buffer_load_dwordx4 v[80:83], v28, s[24:27], s72 offen sc1
    buffer_load_dwordx4 v[84:87], v29, s[24:27], s72 offen sc1
    buffer_load_dwordx4 v[88:91], v30, s[24:27], s72 offen sc1
    buffer_load_dwordx4 v[92:95], v31, s[24:27], s72 offen sc1
L_g_chk:
    s_waitcnt vmcnt(0)
    v_perm_b32 v20, v65, v64, s30
    v_perm_b32 v21, v67, v66, s31
    v_or_b32 v20, v20, v21
    v_xor_b32 v22, s28, v20
    v_perm_b32 v20, v69, v68, s30
    v_perm_b32 v21, v71, v70, s31
    v_or_b32 v20, v20, v21
    v_xor_b32 v20, s28, v20
    v_or_b32 v22, v22, v20
    v_perm_b32 v20, v73, v72, s30
    v_perm_b32 v21, v75, v74, s31
    v_or_b32 v20, v20, v21
    v_xor_b32 v20, s28, v20
    v_or_b32 v22, v22, v20
    v_perm_b32 v20, v77, v76, s30
    v_perm_b32 v21, v79, v78, s31
    v_or_b32 v20, v20, v21
    v_xor_b32 v20, s28, v20
    v_or_b32 v22, v22, v20
    v_perm_b32 v20, v81, v80, s30
    v_perm_b32 v21, v83, v82, s31
    v_or_b32 v20, v20, v21
    v_xor_b32 v20, s28, v20
    v_or_b32 v22, v22, v20
    v_perm_b32 v20, v85, v84, s30
    v_perm_b32 v21, v87, v86, s31
    v_or_b32 v20, v20, v21
    v_xor_b32 v20, s28, v20
    v_or_b32 v22, v22, v20
    v_perm_b32 v20, v89, v88, s30
    v_perm_b32 v21, v91, v90, s31
    v_or_b32 v20, v20, v21
    v_xor_b32 v20, s28, v20
    v_or_b32 v22, v22, v20
    v_perm_b32 v20, v93, v92, s30
    v_perm_b32 v21, v95, v94, s31
    v_or_b32 v20, v20, v21
    v_xor_b32 v20, s28, v20
    v_or_b32 v22, v22, v20
    v_cmp_ne_u32 vcc, 0, v22
    s_cbranch_vccz L_g_ok
    s_sub_u32 s82, s82, 1
    s_cmp_lg_u32 s82, 0
    s_cbranch_scc1 L_g_loop
    s_endpgm
L_g_ok:
    v_and_b32 v64, s29, v64
    v_and_b32 v65, s29, v65
    v_and_b32 v66, s29, v66
    v_and_b32 v67, s29, v67
    v_and_b32 v68, s29, v68
    v_and_b32 v69, s29, v69
    v_and_b32 v70, s29, v70
    v_and_b32 v71, s29, v71
    v_add_f32 v64, v64, v68
    v_add_f32 v65, v65, v69
    v_add_f32 v66, v66, v70
    v_add_f32 v67, v67, v71
    s_nop 1
    v_permlane32_swap_b32 v64, v66
    v_permlane32_swap_b32 v65, v67
    s_nop 0
    v_add_f32 v64, v64, v66
    v_add_f32 v65, v65, v67
    v_cvt_pk_bf16_f32 v64, v64, v65
    ds_write_b16 v6, v64 offset:1280
    ds_write_b16_d16_hi v6, v64 offset:1312
    v_and_b32 v72, s29, v72
    v_and_b32 v73, s29, v73
    v_and_b32 v74, s29, v74
    v_and_b32 v75, s29, v75
    v_and_b32 v76, s29, v76
    v_and_b32 v77, s29, v77
    v_and_b32 v78, s29, v78
    v_and_b32 v79, s29, v79
    v_add_f32 v72, v72, v76
    v_add_f32 v73, v73, v77
    v_add_f32 v74, v74, v78
    v_add_f32 v75, v75, v79
    s_nop 1
    v_permlane32_swap_b32 v72, v74
    v_permlane32_swap_b32 v73, v75
    s_nop 0
    v_add_f32 v72, v72, v74
    v_add_f32 v73, v73, v75
    v_cvt_pk_bf16_f32 v72, v72, v73
    ds_write_b16 v6, v72 offset:1536
    ds_write_b16_d16_hi v6, v72 offset:1568
    v_and_b32 v80, s29, v80
    v_and_b32 v81, s29, v81
    v_and_b32 v82, s29, v82
    v_and_b32 v83, s29, v83
    v_and_b32 v84, s29, v84
    v_and_b32 v85, s29, v85
    v_and_b32 v86, s29, v86
    v_and_b32 v87, s29, v87
    v_add_f32 v80, v80, v84
    v_add_f32 v81, v81, v85
    v_add_f32 v82, v82, v86
    v_add_f32 v83, v83, v87
    s_nop 1
    v_permlane32_swap_b32 v80, v82
    v_permlane32_swap_b32 v81, v83
    s_nop 0
    v_add_f32 v80, v80, v82
    v_add_f32 v81, v81, v83
    v_cvt_pk_bf16_f32 v80, v80, v81
    ds_write_b16 v6, v80 offset:1792
    ds_write_b16_d16_hi v6, v80 offset:1824
    v_and_b32 v88, s29, v88
    v_and_b32 v89, s29, v89
    v_and_b32 v90, s29, v90
    v_and_b32 v91, s29, v91
    v_and_b32 v92, s29, v92
    v_and_b32 v93, s29, v93
    v_and_b32 v94, s29, v94
    v_and_b32 v95, s29, v95
    v_add_f32 v88, v88, v92
    v_add_f32 v89, v89, v93
    v_add_f32 v90, v90, v94
    v_add_f32 v91, v91, v95
    s_nop 1
    v_permlane32_swap_b32 v88, v90
    v_permlane32_swap_b32 v89, v91
    s_nop 0
    v_add_f32 v88, v88, v90
    v_add_f32 v89, v89, v91
    v_cvt_pk_bf16_f32 v88, v88, v89
    ds_write_b16 v6, v88 offset:2048
    ds_write_b16_d16_hi v6, v88 offset:2080
    v_mov_b32 v20, 24
    v_mov_b32 v21, 1
    s_mov_b64 exec, 1
    ds_write_b32 v20, v21
    s_mov_b64 exec, -1
L_h_b3:
    s_setprio 3
    s_cmp_eq_u32 s66, 3
    s_cbranch_scc1 L_hfin
    s_mov_b32 s74, 8388608
    s_mov_b32 s76, 6291456
    s_cmp_lg_u32 s66, 0
    s_cbranch_scc1 L_proj
    v_and_b32 v144, 7, v0
    v_lshlrev_b32 v144, 4, v144
    v_bfe_i32 v145, v0, 3, 1
    v_and_b32 v145, 0x8180, v145
    v_xor_b32 v144, v144, v145
    v_bfe_i32 v145, v0, 4, 1
    v_and_b32 v145, 0x10200, v145
    v_xor_b32 v144, v144, v145
    v_bfe_i32 v145, v0, 5, 1
    v_and_b32 v145, 0x20400, v145
    v_xor_b32 v144, v144, v145
    s_lshl2_add_u32 s4, s68, s69
    s_lshl3_add_u32 s4, s4, s67
    s_lshl_b32 s4, s4, 7
    s_xor_b32 s4, s4, 0x10200
    v_xor_b32 v144, s4, v144
    v_mov_b32 v58, 4
L_sp_125:
    ds_read_b32 v57, v58
    s_waitcnt lgkmcnt(0)
    v_readfirstlane_b32 s4, v57
    s_nop 0
    s_cmp_ge_u32 s4, 500
    s_cbranch_scc1 L_ok_126
    s_sleep 2
    s_sub_u32 s82, s82, 1
    s_cmp_lg_u32 s82, 0
    s_cbranch_scc1 L_sp_125
    s_endpgm
L_ok_126:
    s_mov_b64 exec, 0xffff
    buffer_store_dwordx4 v[140:143], v144, s[24:27], s74 offen sc1
    s_branch L_hfin
L_proj:
    s_and_b32 s70, s66, 1
    s_cselect_b32 s8, s54, s44
    s_cselect_b32 s9, s55, s45
    s_and_b32 s9, s9, 0xffff
    s_mov_b32 s10, 0x400000
    s_mov_b32 s11, 0x20000
    s_mov_b32 s12, s56
    s_and_b32 s13, s57, 0xffff
    s_mov_b32 s14, 0x4000
    s_mov_b32 s15, 0x20000
    v_lshrrev_b32 v4, 3, v0
    v_and_b32 v5, 7, v0
    v_lshlrev_b32 v4, 10, v4
    v_lshl_add_u32 v4, v5, 4, v4
    v_xor_b32 v5, 32, v4
    v_xor_b32 v6, 64, v4
    v_xor_b32 v7, 96, v4
    s_lshl_b32 s72, s63, 17
    s_lshl_b32 s4, s62, 7
    s_add_u32 s72, s72, s4
    s_mul_i32 s73, s70, -25600
    s_add_u32 s73, s73, 58368
    s_mov_b32 m0, s73
    v_lshrrev_b32 v3, 4, v0
    v_bfe_u32 v12, v0, 2, 2
    v_and_b32 v13, 3, v0
    v_lshl_add_u32 v8, v12, 3, v3
    v_lshlrev_b32 v8, 7, v8
    v_lshl_add_u32 v8, v13, 3, v8
    v_lshl_add_u32 v8, v12, 5, v8
    v_add_u32 v8, s73, v8
    v_xor_b32 v9, 32, v8
    v_xor_b32 v10, 64, v8
    v_xor_b32 v11, 96, v8
    v_and_b32 v136, 1, v0
    v_lshl_add_u32 v136, v136, 2, v12
    v_lshlrev_b32 v136, 7, v136
    v_lshl_add_u32 v136, v3, 4, v136
    s_lshl_b32 s5, s63, 10
    s_bitcmp1_b32 s66, 1
    s_cselect_b32 s4, 0x10200, 0
    s_xor_b32 s5, s5, s4
    v_xor_b32 v136, s5, v136
    v_xor_b32 v137, 0x40, v136
    v_xor_b32 v138, 0x8180, v136
    v_xor_b32 v139, 0x81c0, v136
    v_and_b32 v60, 7, v0
    v_lshlrev_b32 v60, 4, v60
    v_bfe_i32 v61, v0, 3, 1
    v_and_b32 v61, 0x1000, v61
    v_xor_b32 v60, v60, v61
    v_bfe_i32 v61, v0, 4, 1
    v_and_b32 v61, 0x2000, v61
    v_xor_b32 v60, v60, v61
    v_bfe_i32 v61, v0, 5, 1
    v_and_b32 v61, 0x4000, v61
    v_xor_b32 v60, v60, v61
    s_lshl_b32 s5, s62, 17
    s_lshl_b32 s4, s63, 7
    s_or_b32 s5, s5, s4
    s_bitcmp1_b32 s70, 0
    s_cselect_b32 s4, 0x10000, 0
    s_xor_b32 s5, s5, s4
    v_xor_b32 v60, s5, v60
    v_xor_b32 v63, 0x8000, v60
    v_lshrrev_b32 v61, 2, v0
    v_lshlrev_b32 v61, 7, v61
    v_lshl_add_u32 v61, v13, 4, v61
    s_lshl_b32 s5, s62, 17
    s_bitcmp1_b32 s63, 0
    s_cselect_b32 s4, 0x40, 0
    s_xor_b32 s5, s5, s4
    s_bitcmp1_b32 s63, 1
    s_cselect_b32 s4, 0x1000, 0
    s_xor_b32 s5, s5, s4
    s_bitcmp1_b32 s63, 2
    s_cselect_b32 s4, 0x2000, 0
    s_xor_b32 s5, s5, s4
    s_bitcmp1_b32 s63, 3
    s_cselect_b32 s4, 0x4000, 0
    s_xor_b32 s5, s5, s4
    s_bitcmp1_b32 s63, 4
    s_cselect_b32 s4, 0x8000, 0
    s_xor_b32 s5, s5, s4
    s_bitcmp1_b32 s70, 0
    s_cselect_b32 s4, 0x10000, 0
    s_xor_b32 s5, s5, s4
    v_xor_b32 v61, s5, v61
    v_xor_b32 v14, 0x800, v61
    s_lshr_b32 s4, s63, 2
    s_lshl_b32 s79, s4, 11
    s_and_b32 s4, s63, 3
    s_lshl_b32 s5, s4, 3
    s_add_u32 s79, s79, s5
    s_lshl_b32 s5, s70, 10
    s_add_u32 s79, s79, s5
    s_lshl_b32 s5, s62, 7
    s_add_u32 s79, s79, s5
    v_lshlrev_b32 v62, 5, v3
    v_lshl_add_u32 v62, v13, 1, v62
    s_bfe_u32 s4, s28, 0x80000
    v_mov_b32 v128, s4
    s_bfe_u32 s4, s28, 0x80008
    v_mov_b32 v129, s4
    s_bfe_u32 s4, s28, 0x80010
    v_mov_b32 v130, s4
    s_bfe_u32 s4, s28, 0x80018
    v_mov_b32 v131, s4
    v_mov_b32 v16, 0
    v_mov_b32 v17, 0
    v_mov_b32 v18, 0
    v_mov_b32 v19, 0
    v_mov_b32 v20, 0
    v_mov_b32 v21, 0
    v_mov_b32 v22, 0
    v_mov_b32 v23, 0
    v_mov_b32 v24, 0
    v_mov_b32 v25, 0
    v_mov_b32 v26, 0
    v_mov_b32 v27, 0
    v_mov_b32 v28, 0
    v_mov_b32 v29, 0
    v_mov_b32 v30, 0
    v_mov_b32 v31, 0
    s_cmp_eq_u32 s70, 0
    s_cbranch_scc1 L_trig
L_ctl:
    v_mov_b32 v58, 4
    v_lshlrev_b32 v53, 3, v0
    v_mov_b32 v55, s28
    s_lshr_b32 s4, s63, 4
    s_lshl1_add_u32 s4, s62, s4
    s_lshl_b32 s4, s4, 3
    v_mov_b32 v52, s4
    s_and_b32 s35, s63, 15
    s_lshl_b32 s4, s62, 1
    s_xor_b32 s35, s35, s4
    s_mov_b32 s34, 0
    s_mov_b32 s78, 14029
    s_mov_b32 s33, 2686976
L_sp_127:
    ds_read_b32 v57, v58
    s_waitcnt lgkmcnt(0)
    v_readfirstlane_b32 s4, v57
    s_nop 0
    s_cmp_ge_u32 s4, 20
    s_cbranch_scc1 L_ok_128
    s_sleep 8
    s_sub_u32 s82, s82, 1
    s_cmp_lg_u32 s82, 0
    s_cbranch_scc1 L_sp_127
    s_endpgm
L_ok_128:
L_sp_129:
    ds_read_b32 v57, v58
    s_waitcnt lgkmcnt(0)
    v_readfirstlane_b32 s4, v57
    s_nop 0
    s_cmp_ge_u32 s4, 24
    s_cbranch_scc1 L_ok_130
    s_sleep 2
    s_sub_u32 s82, s82, 1
    s_cmp_lg_u32 s82, 0
    s_cbranch_scc1 L_sp_129
    s_endpgm
L_ok_130:
    s_memrealtime s[6:7]
    s_waitcnt lgkmcnt(0)
    s_mov_b32 s32, s6
    v_mov_b32 v54, s6
    s_cmp_lg_u32 s35, 0
    s_cbranch_scc1 L_cp0
    s_mov_b64 exec, 1
    buffer_store_dwordx2 v[54:55], v52, s[24:27], s33 offen sc1
    s_mov_b64 exec, -1
L_cp0:
L_sp_131:
    ds_read_b32 v57, v58
    s_waitcnt lgkmcnt(0)
    v_readfirstlane_b32 s4, v57
    s_nop 0
    s_cmp_ge_u32 s4, 40
    s_cbranch_scc1 L_ok_132
    s_sleep 8
    s_sub_u32 s82, s82, 1
    s_cmp_lg_u32 s82, 0
    s_cbranch_scc1 L_sp_131
    s_endpgm
L_ok_132:
    s_mov_b64 exec, 0xffff
    buffer_load_dwordx2 v[50:51], v53, s[24:27], s33 offen
    s_memrealtime s[6:7]
    s_waitcnt lgkmcnt(0)
    s_sub_u32 s6, s6, s32
    v_mov_b32 v49, s6
    s_mov_b32 s7, 0x80000000
    s_mov_b32 s83, 0
    s_waitcnt vmcnt(0)
    v_subrev_u32 v50, s32, v50
    v_cmp_eq_u32 vcc, s28, v51
    ds_read_b32 v57, v58
    v_cndmask_b32 v50, v49, v50, vcc
L_cr0:
    s_nop 0
    v_readlane_b32 s4, v50, s83
    s_nop 3
    v_cmp_gt_i32 vcc, s4, v50
    s_nop 3
    s_bcnt1_i32_b32 s5, vcc_lo
    s_cmp_le_u32 s5, 7
    s_cselect_b32 s4, s4, s7
    s_max_i32 s7, s7, s4
    s_add_u32 s83, s83, 1
    s_cmp_lt_u32 s83, 16
    s_cbranch_scc1 L_cr0
    s_mov_b64 exec, -1
    s_sub_u32 s5, 0, s7
    s_add_u32 s7, s7, s32
    s_sub_u32 s5, s7, s34
    s_mov_b32 s34, s7
    s_waitcnt lgkmcnt(0)
    s_mul_i32 s4, s78, 10
    s_lshr_b32 s4, s4, 8
    s_sub_u32 s7, s7, s4
    s_sub_u32 s7, s7, 10
    v_mov_b32 v56, s7
    v_mov_b32 v57, s78
    ds_write_b64 v58, v[56:57] offset:92
    s_mov_b32 s33, 2687360
L_sp_133:
    ds_read_b32 v57, v58
    s_waitcnt lgkmcnt(0)
    v_readfirstlane_b32 s4, v57
    s_nop 0
    s_cmp_ge_u32 s4, 68
    s_cbranch_scc1 L_ok_134
    s_sleep 8
    s_sub_u32 s82, s82, 1
    s_cmp_lg_u32 s82, 0
    s_cbranch_scc1 L_sp_133
    s_endpgm
L_ok_134:
L_sp_135:
    ds_read_b32 v57, v58
    s_waitcnt lgkmcnt(0)
    v_readfirstlane_b32 s4, v57
    s_nop 0
    s_cmp_ge_u32 s4, 72
    s_cbranch_scc1 L_ok_136
    s_sleep 2
    s_sub_u32 s82, s82, 1
    s_cmp_lg_u32 s82, 0
    s_cbranch_scc1 L_sp_135
    s_endpgm
L_ok_136:
    s_memrealtime s[6:7]
    s_waitcnt lgkmcnt(0)
    s_mov_b32 s32, s6
    v_mov_b32 v54, s6
    s_cmp_lg_u32 s35, 0
    s_cbranch_scc1 L_cp1
    s_mov_b64 exec, 1
    buffer_store_dwordx2 v[54:55], v52, s[24:27], s33 offen sc1
    s_mov_b64 exec, -1
L_cp1:
L_sp_137:
    ds_read_b32 v57, v58
    s_waitcnt lgkmcnt(0)
    v_readfirstlane_b32 s4, v57
    s_nop 0
    s_cmp_ge_u32 s4, 92
    s_cbranch_scc1 L_ok_138
    s_sleep 8
    s_sub_u32 s82, s82, 1
    s_cmp_lg_u32 s82, 0
    s_cbranch_scc1 L_sp_137
    s_endpgm
L_ok_138:
    s_mov_b64 exec, 0xffff
    buffer_load_dwordx2 v[50:51], v53, s[24:27], s33 offen
    s_memrealtime s[6:7]
    s_waitcnt lgkmcnt(0)
    s_sub_u32 s6, s6, s32
    v_mov_b32 v49, s6
    s_mov_b32 s7, 0x80000000
    s_mov_b32 s83, 0
    s_waitcnt vmcnt(0)
    s_mov_b32 s80, s7
    v_subrev_u32 v50, s32, v50
    v_cmp_eq_u32 vcc, s28, v51
    ds_read_b32 v57, v58
    v_cndmask_b32 v50, v49, v50, vcc
L_cr1:
    s_nop 0
    v_readlane_b32 s4, v50, s83
    s_nop 3
    v_cmp_gt_i32 vcc, s4, v50
    s_nop 3
    s_bcnt1_i32_b32 s5, vcc_lo
    s_cmp_le_u32 s5, 13
    s_cselect_b32 s6, s4, s80
    s_max_i32 s80, s80, s6
    s_cmp_le_u32 s5, 7
    s_cselect_b32 s4, s4, s7
    s_max_i32 s7, s7, s4
    s_add_u32 s83, s83, 1
    s_cmp_lt_u32 s83, 16
    s_cbranch_scc1 L_cr1
    s_mov_b64 exec, -1
    s_sub_u32 s5, 0, s7
    s_sub_u32 s80, s80, 20
    s_max_i32 s80, s80, s7
    s_sub_u32 s80, s80, s7
    s_add_u32 s7, s7, s32
    s_sub_u32 s5, s7, s34
    s_mov_b32 s34, s7
    s_waitcnt lgkmcnt(0)
    s_add_u32 s7, s7, s80
    s_add_u32 s6, s78, 179
    s_mul_i32 s78, s5, 5407
    s_lshr_b32 s78, s78, 8
    s_min_u32 s78, s78, s6
    s_mul_i32 s4, s78, 22
    s_lshr_b32 s4, s4, 8
    s_sub_u32 s7, s7, s4
    s_sub_u32 s7, s7, 10
    v_mov_b32 v56, s7
    v_mov_b32 v57, s78
    ds_write_b64 v58, v[56:57] offset:92
    s_mov_b32 s33, 2687744
L_sp_139:
    ds_read_b32 v57, v58
    s_waitcnt lgkmcnt(0)
    v_readfirstlane_b32 s4, v57
    s_nop 0
    s_cmp_ge_u32 s4, 140
    s_cbranch_scc1 L_ok_140
    s_sleep 8
    s_sub_u32 s82, s82, 1
    s_cmp_lg_u32 s82, 0
    s_cbranch_scc1 L_sp_139
    s_endpgm
L_ok_140:
L_sp_141:
    ds_read_b32 v57, v58
    s_waitcnt lgkmcnt(0)
    v_readfirstlane_b32 s4, v57
    s_nop 0
    s_cmp_ge_u32 s4, 144
    s_cbranch_scc1 L_ok_142
    s_sleep 2
    s_sub_u32 s82, s82, 1
    s_cmp_lg_u32 s82, 0
    s_cbranch_scc1 L_sp_141
    s_endpgm
L_ok_142:
    s_memrealtime s[6:7]
    s_waitcnt lgkmcnt(0)
    s_mov_b32 s32, s6
    v_mov_b32 v54, s6
    s_cmp_lg_u32 s35, 0
    s_cbranch_scc1 L_cp2
    s_mov_b64 exec, 1
    buffer_store_dwordx2 v[54:55], v52, s[24:27], s33 offen sc1
    s_mov_b64 exec, -1
L_cp2:
L_sp_143:
    ds_read_b32 v57, v58
    s_waitcnt lgkmcnt(0)
    v_readfirstlane_b32 s4, v57
    s_nop 0
    s_cmp_ge_u32 s4, 160
    s_cbranch_scc1 L_ok_144
    s_sleep 8
    s_sub_u32 s82, s82, 1
    s_cmp_lg_u32 s82, 0
    s_cbranch_scc1 L_sp_143
    s_endpgm
L_ok_144:
    s_mov_b64 exec, 0xffff
    buffer_load_dwordx2 v[50:51], v53, s[24:27], s33 offen
    s_memrealtime s[6:7]
    s_waitcnt lgkmcnt(0)
    s_sub_u32 s6, s6, s32
    v_mov_b32 v49, s6
    s_mov_b32 s7, 0x80000000
    s_mov_b32 s83, 0
    s_waitcnt vmcnt(0)
    s_mov_b32 s80, s7
    v_subrev_u32 v50, s32, v50
    v_cmp_eq_u32 vcc, s28, v51
    ds_read_b32 v57, v58
    v_cndmask_b32 v50, v49, v50, vcc
L_cr2:
    s_nop 0
    v_readlane_b32 s4, v50, s83
    s_nop 3
    v_cmp_gt_i32 vcc, s4, v50
    s_nop 3
    s_bcnt1_i32_b32 s5, vcc_lo
    s_cmp_le_u32 s5, 13
    s_cselect_b32 s6, s4, s80
    s_max_i32 s80, s80, s6
    s_cmp_le_u32 s5, 7
    s_cselect_b32 s4, s4, s7
    s_max_i32 s7, s7, s4
    s_add_u32 s83, s83, 1
    s_cmp_lt_u32 s83, 16
    s_cbranch_scc1 L_cr2
    s_mov_b64 exec, -1
    s_sub_u32 s5, 0, s7
    s_sub_u32 s80, s80, 20
    s_max_i32 s80, s80, s7
    s_sub_u32 s80, s80, s7
    s_add_u32 s7, s7, s32
    s_sub_u32 s5, s7, s34
    s_mov_b32 s34, s7
    s_waitcnt lgkmcnt(0)
    s_add_u32 s7, s7, s80
    s_add_u32 s6, s78, 179
    s_mul_i32 s78, s5, 3604
    s_lshr_b32 s78, s78, 8
    s_min_u32 s78, s78, s6
    s_mul_i32 s4, s78, 40
    s_lshr_b32 s4, s4, 8
    s_sub_u32 s7, s7, s4
    s_sub_u32 s7, s7, 10
    v_mov_b32 v56, s7
    v_mov_b32 v57, s78
    ds_write_b64 v58, v[56:57] offset:92
    s_mov_b32 s33, 2688128
L_sp_145:
    ds_read_b32 v57, v58
    s_waitcnt lgkmcnt(0)
    v_readfirstlane_b32 s4, v57
    s_nop 0
    s_cmp_ge_u32 s4, 204
    s_cbranch_scc1 L_ok_146
    s_sleep 8
    s_sub_u32 s82, s82, 1
    s_cmp_lg_u32 s82, 0
    s_cbranch_scc1 L_sp_145
    s_endpgm
L_ok_146:
L_sp_147:
    ds_read_b32 v57, v58
    s_waitcnt lgkmcnt(0)
    v_readfirstlane_b32 s4, v57
    s_nop 0
    s_cmp_ge_u32 s4, 208
    s_cbranch_scc1 L_ok_148
    s_sleep 2
    s_sub_u32 s82, s82, 1
    s_cmp_lg_u32 s82, 0
    s_cbranch_scc1 L_sp_147
    s_endpgm
L_ok_148:
    s_memrealtime s[6:7]
    s_waitcnt lgkmcnt(0)
    s_mov_b32 s32, s6
    v_mov_b32 v54, s6
    s_cmp_lg_u32 s35, 0
    s_cbranch_scc1 L_cp3
    s_mov_b64 exec, 1
    buffer_store_dwordx2 v[54:55], v52, s[24:27], s33 offen sc1
    s_mov_b64 exec, -1
L_cp3:
L_sp_149:
    ds_read_b32 v57, v58
    s_waitcnt lgkmcnt(0)
    v_readfirstlane_b32 s4, v57
    s_nop 0
    s_cmp_ge_u32 s4, 220
    s_cbranch_scc1 L_ok_150
    s_sleep 8
    s_sub_u32 s82, s82, 1
    s_cmp_lg_u32 s82, 0
    s_cbranch_scc1 L_sp_149
    s_endpgm
L_ok_150:
    s_mov_b64 exec, 0xffff
    buffer_load_dwordx2 v[50:51], v53, s[24:27], s33 offen
    s_memrealtime s[6:7]
    s_waitcnt lgkmcnt(0)
    s_sub_u32 s6, s6, s32
    v_mov_b32 v49, s6
    s_mov_b32 s7, 0x80000000
    s_mov_b32 s83, 0
    s_waitcnt vmcnt(0)
    s_mov_b32 s80, s7
    v_subrev_u32 v50, s32, v50
    v_cmp_eq_u32 vcc, s28, v51
    ds_read_b32 v57, v58
    v_cndmask_b32 v50, v49, v50, vcc
L_cr3:
    s_nop 0
    v_readlane_b32 s4, v50, s83
    s_nop 3
    v_cmp_gt_i32 vcc, s4, v50
    s_nop 3
    s_bcnt1_i32_b32 s5, vcc_lo
    s_cmp_le_u32 s5, 13
    s_cselect_b32 s6, s4, s80
    s_max_i32 s80, s80, s6
    s_cmp_le_u32 s5, 7
    s_cselect_b32 s4, s4, s7
    s_max_i32 s7, s7, s4
    s_add_u32 s83, s83, 1
    s_cmp_lt_u32 s83, 16
    s_cbranch_scc1 L_cr3
    s_mov_b64 exec, -1
    s_sub_u32 s5, 0, s7
    s_sub_u32 s80, s80, 20
    s_max_i32 s80, s80, s7
    s_sub_u32 s80, s80, s7
    s_add_u32 s7, s7, s32
    s_sub_u32 s5, s7, s34
    s_mov_b32 s34, s7
    s_waitcnt lgkmcnt(0)
    s_add_u32 s7, s7, s80
    s_add_u32 s6, s78, 179
    s_mul_i32 s78, s5, 4055
    s_lshr_b32 s78, s78, 8
    s_min_u32 s78, s78, s6
    s_mul_i32 s4, s78, 56
    s_lshr_b32 s4, s4, 8
    s_sub_u32 s7, s7, s4
    s_sub_u32 s7, s7, 10
    v_mov_b32 v56, s7
    v_mov_b32 v57, s78
    ds_write_b64 v58, v[56:57] offset:92
    s_mov_b32 s33, 2688512
L_sp_151:
    ds_read_b32 v57, v58
    s_waitcnt lgkmcnt(0)
    v_readfirstlane_b32 s4, v57
    s_nop 0
    s_cmp_ge_u32 s4, 284
    s_cbranch_scc1 L_ok_152
    s_sleep 8
    s_sub_u32 s82, s82, 1
    s_cmp_lg_u32 s82, 0
    s_cbranch_scc1 L_sp_151
    s_endpgm
L_ok_152:
L_sp_153:
    ds_read_b32 v57, v58
    s_waitcnt lgkmcnt(0)
    v_readfirstlane_b32 s4, v57
    s_nop 0
    s_cmp_ge_u32 s4, 288
    s_cbranch_scc1 L_ok_154
    s_sleep 2
    s_sub_u32 s82, s82, 1
    s_cmp_lg_u32 s82, 0
    s_cbranch_scc1 L_sp_153
    s_endpgm
L_ok_154:
    s_memrealtime s[6:7]
    s_waitcnt lgkmcnt(0)
    s_mov_b32 s32, s6
    v_mov_b32 v54, s6
    s_cmp_lg_u32 s35, 0
    s_cbranch_scc1 L_cp4
    s_mov_b64 exec, 1
    buffer_store_dwordx2 v[54:55], v52, s[24:27], s33 offen sc1
    s_mov_b64 exec, -1
L_cp4:
L_sp_155:
    ds_read_b32 v57, v58
    s_waitcnt lgkmcnt(0)
    v_readfirstlane_b32 s4, v57
    s_nop 0
    s_cmp_ge_u32 s4, 300
    s_cbranch_scc1 L_ok_156
    s_sleep 8
    s_sub_u32 s82, s82, 1
    s_cmp_lg_u32 s82, 0
    s_cbranch_scc1 L_sp_155
    s_endpgm
L_ok_156:
    s_mov_b64 exec, 0xffff
    buffer_load_dwordx2 v[50:51], v53, s[24:27], s33 offen
    s_memrealtime s[6:7]
    s_waitcnt lgkmcnt(0)
    s_sub_u32 s6, s6, s32
    v_mov_b32 v49, s6
    s_mov_b32 s7, 0x80000000
    s_mov_b32 s83, 0
    s_waitcnt vmcnt(0)
    s_mov_b32 s80, s7
    v_subrev_u32 v50, s32, v50
    v_cmp_eq_u32 vcc, s28, v51
    ds_read_b32 v57, v58
    v_cndmask_b32 v50, v49, v50, vcc
L_cr4:
    s_nop 0
    v_readlane_b32 s4, v50, s83
    s_nop 3
    v_cmp_gt_i32 vcc, s4, v50
    s_nop 3
    s_bcnt1_i32_b32 s5, vcc_lo
    s_cmp_le_u32 s5, 13
    s_cselect_b32 s6, s4, s80
    s_max_i32 s80, s80, s6
    s_cmp_le_u32 s5, 7
    s_cselect_b32 s4, s4, s7
    s_max_i32 s7, s7, s4
    s_add_u32 s83, s83, 1
    s_cmp_lt_u32 s83, 16
    s_cbranch_scc1 L_cr4
    s_mov_b64 exec, -1
    s_sub_u32 s5, 0, s7
    s_sub_u32 s80, s80, 20
    s_max_i32 s80, s80, s7
    s_sub_u32 s80, s80, s7
    s_add_u32 s7, s7, s32
    s_sub_u32 s5, s7, s34
    s_mov_b32 s34, s7
    s_waitcnt lgkmcnt(0)
    s_add_u32 s7, s7, s80
    s_mul_i32 s4, s78, 76
    s_lshr_b32 s4, s4, 8
    s_sub_u32 s7, s7, s4
    s_sub_u32 s7, s7, 10
    v_mov_b32 v56, s7
    v_mov_b32 v57, s78
    ds_write_b64 v58, v[56:57] offset:92
    s_mov_b32 s33, 2688896
L_sp_157:
    ds_read_b32 v57, v58
    s_waitcnt lgkmcnt(0)
    v_readfirstlane_b32 s4, v57
    s_nop 0
    s_cmp_ge_u32 s4, 348
    s_cbranch_scc1 L_ok_158
    s_sleep 8
    s_sub_u32 s82, s82, 1
    s_cmp_lg_u32 s82, 0
    s_cbranch_scc1 L_sp_157
    s_endpgm
L_ok_158:
L_sp_159:
    ds_read_b32 v57, v58
    s_waitcnt lgkmcnt(0)
    v_readfirstlane_b32 s4, v57
    s_nop 0
    s_cmp_ge_u32 s4, 352
    s_cbranch_scc1 L_ok_160
    s_sleep 2
    s_sub_u32 s82, s82, 1
    s_cmp_lg_u32 s82, 0
    s_cbranch_scc1 L_sp_159
    s_endpgm
L_ok_160:
    s_memrealtime s[6:7]
    s_waitcnt lgkmcnt(0)
    s_mov_b32 s32, s6
    v_mov_b32 v54, s6
    s_cmp_lg_u32 s35, 0
    s_cbranch_scc1 L_cp5
    s_mov_b64 exec, 1
    buffer_store_dwordx2 v[54:55], v52, s[24:27], s33 offen sc1
    s_mov_b64 exec, -1
L_cp5:
L_sp_161:
    ds_read_b32 v57, v58
    s_waitcnt lgkmcnt(0)
    v_readfirstlane_b32 s4, v57
    s_nop 0
    s_cmp_ge_u32 s4, 364
    s_cbranch_scc1 L_ok_162
    s_sleep 8
    s_sub_u32 s82, s82, 1
    s_cmp_lg_u32 s82, 0
    s_cbranch_scc1 L_sp_161
    s_endpgm
L_ok_162:
    s_mov_b64 exec, 0xffff
    buffer_load_dwordx2 v[50:51], v53, s[24:27], s33 offen
    s_memrealtime s[6:7]
    s_waitcnt lgkmcnt(0)
    s_sub_u32 s6, s6, s32
    v_mov_b32 v49, s6
    s_mov_b32 s7, 0x80000000
    s_mov_b32 s83, 0
    s_waitcnt vmcnt(0)
    s_mov_b32 s80, s7
    v_subrev_u32 v50, s32, v50
    v_cmp_eq_u32 vcc, s28, v51
    ds_read_b32 v57, v58
    v_cndmask_b32 v50, v49, v50, vcc
L_cr5:
    s_nop 0
    v_readlane_b32 s4, v50, s83
    s_nop 3
    v_cmp_gt_i32 vcc, s4, v50
    s_nop 3
    s_bcnt1_i32_b32 s5, vcc_lo
    s_cmp_le_u32 s5, 13
    s_cselect_b32 s6, s4, s80
    s_max_i32 s80, s80, s6
    s_cmp_le_u32 s5, 7
    s_cselect_b32 s4, s4, s7
    s_max_i32 s7, s7, s4
    s_add_u32 s83, s83, 1
    s_cmp_lt_u32 s83, 16
    s_cbranch_scc1 L_cr5
    s_mov_b64 exec, -1
    s_sub_u32 s5, 0, s7
    s_sub_u32 s80, s80, 20
    s_max_i32 s80, s80, s7
    s_sub_u32 s80, s80, s7
    s_add_u32 s7, s7, s32
    s_sub_u32 s5, s7, s34
    s_mov_b32 s34, s7
    s_waitcnt lgkmcnt(0)
    s_add_u32 s7, s7, s80
    s_add_u32 s6, s78, 179
    s_mul_i32 s78, s5, 4055
    s_lshr_b32 s78, s78, 8
    s_min_u32 s78, s78, s6
    s_mul_i32 s4, s78, 92
    s_lshr_b32 s4, s4, 8
    s_sub_u32 s7, s7, s4
    s_sub_u32 s7, s7, 10
    v_mov_b32 v56, s7
    v_mov_b32 v57, s78
    ds_write_b64 v58, v[56:57] offset:92
    s_mov_b32 s33, 2689280
L_sp_163:
    ds_read_b32 v57, v58
    s_waitcnt lgkmcnt(0)
    v_readfirstlane_b32 s4, v57
    s_nop 0
    s_cmp_ge_u32 s4, 412
    s_cbranch_scc1 L_ok_164
    s_sleep 8
    s_sub_u32 s82, s82, 1
    s_cmp_lg_u32 s82, 0
    s_cbranch_scc1 L_sp_163
    s_endpgm
L_ok_164:
L_sp_165:
    ds_read_b32 v57, v58
    s_waitcnt lgkmcnt(0)
    v_readfirstlane_b32 s4, v57
    s_nop 0
    s_cmp_ge_u32 s4, 416
    s_cbranch_scc1 L_ok_166
    s_sleep 2
    s_sub_u32 s82, s82, 1
    s_cmp_lg_u32 s82, 0
    s_cbranch_scc1 L_sp_165
    s_endpgm
L_ok_166:
    s_memrealtime s[6:7]
    s_waitcnt lgkmcnt(0)
    s_mov_b32 s32, s6
    v_mov_b32 v54, s6
    s_cmp_lg_u32 s35, 0
    s_cbranch_scc1 L_cp6
    s_mov_b64 exec, 1
    buffer_store_dwordx2 v[54:55], v52, s[24:27], s33 offen sc1
    s_mov_b64 exec, -1
L_cp6:
L_sp_167:
    ds_read_b32 v57, v58
    s_waitcnt lgkmcnt(0)
    v_readfirstlane_b32 s4, v57
    s_nop 0
    s_cmp_ge_u32 s4, 428
    s_cbranch_scc1 L_ok_168
    s_sleep 8
    s_sub_u32 s82, s82, 1
    s_cmp_lg_u32 s82, 0
    s_cbranch_scc1 L_sp_167
    s_endpgm
L_ok_168:
    s_mov_b64 exec, 0xffff
    buffer_load_dwordx2 v[50:51], v53, s[24:27], s33 offen
    s_memrealtime s[6:7]
    s_waitcnt lgkmcnt(0)
    s_sub_u32 s6, s6, s32
    v_mov_b32 v49, s6
    s_mov_b32 s7, 0x80000000
    s_mov_b32 s83, 0
    s_waitcnt vmcnt(0)
    s_mov_b32 s80, s7
    v_subrev_u32 v50, s32, v50
    v_cmp_eq_u32 vcc, s28, v51
    ds_read_b32 v57, v58
    v_cndmask_b32 v50, v49, v50, vcc
L_cr6:
    s_nop 0
    v_readlane_b32 s4, v50, s83
    s_nop 3
    v_cmp_gt_i32 vcc, s4, v50
    s_nop 3
    s_bcnt1_i32_b32 s5, vcc_lo
    s_cmp_le_u32 s5, 13
    s_cselect_b32 s6, s4, s80
    s_max_i32 s80, s80, s6
    s_cmp_le_u32 s5, 7
    s_cselect_b32 s4, s4, s7
    s_max_i32 s7, s7, s4
    s_add_u32 s83, s83, 1
    s_cmp_lt_u32 s83, 16
    s_cbranch_scc1 L_cr6
    s_mov_b64 exec, -1
    s_sub_u32 s5, 0, s7
    s_sub_u32 s80, s80, 20
    s_max_i32 s80, s80, s7
    s_sub_u32 s80, s80, s7
    s_add_u32 s7, s7, s32
    s_sub_u32 s5, s7, s34
    s_mov_b32 s34, s7
    s_waitcnt lgkmcnt(0)
    s_add_u32 s7, s7, s80
    s_add_u32 s6, s78, 179
    s_mul_i32 s78, s5, 4055
    s_lshr_b32 s78, s78, 8
    s_min_u32 s78, s78, s6
    s_mul_i32 s4, s78, 108
    s_lshr_b32 s4, s4, 8
    s_sub_u32 s7, s7, s4
    s_sub_u32 s7, s7, 10
    v_mov_b32 v56, s7
    v_mov_b32 v57, s78
    ds_write_b64 v58, v[56:57] offset:92
L_trig:
    s_mul_i32 s5, s70, 0
    s_add_u32 s5, s5, 500
    s_sub_u32 s6, s5, 8
    v_mov_b32 v58, 4
L_sp_169:
    ds_read_b32 v57, v58
    s_waitcnt lgkmcnt(0)
    v_readfirstlane_b32 s4, v57
    s_nop 0
    s_cmp_ge_u32 s4, s6
    s_cbranch_scc1 L_ok_170
    s_sleep 16
    s_sub_u32 s82, s82, 1
    s_cmp_lg_u32 s82, 0
    s_cbranch_scc1 L_sp_169
    s_endpgm
L_ok_170:
    ds_read_b32 v57, v2 offset:20
    s_waitcnt lgkmcnt(0)
    v_readfirstlane_b32 s75, v57
    v_not_b32 v32, v128
    v_not_b32 v36, v128
    s_cmp_eq_u32 s75, 0
    s_cbranch_scc1 L_np
    buffer_store_dwordx4 v[32:35], v60, s[24:27], s76 offen
    buffer_store_dwordx4 v[36:39], v63, s[24:27], s76 offen
L_np:
L_sp_171:
    ds_read_b32 v57, v58
    s_waitcnt lgkmcnt(0)
    v_readfirstlane_b32 s4, v57
    s_nop 0
    s_cmp_ge_u32 s4, s5
    s_cbranch_scc1 L_ok_172
    s_sleep 1
    s_sub_u32 s82, s82, 1
    s_cmp_lg_u32 s82, 0
    s_cbranch_scc1 L_sp_171
    s_endpgm
L_ok_172:
    buffer_load_dwordx4 v4, s[8:11], s72 offen nt lds
    s_add_u32 m0, m0, 0x400
    s_add_u32 s72, s72, 0x2000
    buffer_load_dwordx4 v5, s[8:11], s72 offen nt lds
    s_add_u32 m0, m0, 0x400
    s_add_u32 s72, s72, 0x2000
    buffer_load_dwordx4 v6, s[8:11], s72 offen nt lds
    s_add_u32 m0, m0, 0x400
    s_add_u32 s72, s72, 0x2000
    buffer_load_dwordx4 v7, s[8:11], s72 offen nt lds
    s_add_u32 m0, m0, 0x400
    s_add_u32 s72, s72, 0x2000
    buffer_load_dwordx4 v4, s[8:11], s72 offen nt lds
    s_add_u32 m0, m0, 0x400
    s_add_u32 s72, s72, 0x2000
    buffer_load_dwordx4 v5, s[8:11], s72 offen nt lds
    s_add_u32 m0, m0, 0x400
    s_add_u32 s72, s72, 0x2000
    buffer_load_dwordx4 v6, s[8:11], s72 offen nt lds
    s_add_u32 m0, m0, 0x400
    s_add_u32 s72, s72, 0x2000
    buffer_load_dwordx4 v7, s[8:11], s72 offen nt lds
    s_add_u32 m0, m0, 0x400
    s_add_u32 s72, s72, 0x2000
    s_waitcnt vmcnt(7)
    buffer_load_dwordx4 v4, s[8:11], s72 offen nt lds
    s_add_u32 m0, m0, 0x400
    s_add_u32 s72, s72, 0x2000
    s_waitcnt vmcnt(7)
    buffer_load_dwordx4 v5, s[8:11], s72 offen nt lds
    s_add_u32 m0, m0, 0x400
    s_add_u32 s72, s72, 0x2000
    s_waitcnt vmcnt(7)
    buffer_load_dwordx4 v6, s[8:11], s72 offen nt lds
    s_add_u32 m0, m0, 0x400
    s_add_u32 s72, s72, 0x2000
    s_waitcnt vmcnt(7)
    buffer_load_dwordx4 v7, s[8:11], s72 offen nt lds
    s_add_u32 m0, m0, 0x400
    s_add_u32 s72, s72, 0x2000
    s_waitcnt vmcnt(7)
    buffer_load_dwordx4 v4, s[8:11], s72 offen nt lds
    s_add_u32 m0, m0, 0x400
    s_add_u32 s72, s72, 0x2000
    s_waitcnt vmcnt(7)
    buffer_load_dwordx4 v5, s[8:11], s72 offen nt lds
    s_add_u32 m0, m0, 0x400
    s_add_u32 s72, s72, 0x2000
    s_waitcnt vmcnt(7)
    buffer_load_dwordx4 v6, s[8:11], s72 offen nt lds
    s_add_u32 m0, m0, 0x400
    s_add_u32 s72, s72, 0x2000
    s_waitcnt vmcnt(7)
    buffer_load_dwordx4 v7, s[8:11], s72 offen nt lds
L_sp_173:
    ds_read_b32 v57, v58
    s_waitcnt lgkmcnt(0)
    v_readfirstlane_b32 s4, v57
    s_nop 0
    s_cmp_ge_u32 s4, 504
    s_cbranch_scc1 L_ok_174
    s_sleep 1
    s_sub_u32 s82, s82, 1
    s_cmp_lg_u32 s82, 0
    s_cbranch_scc1 L_sp_173
    s_endpgm
L_ok_174:
    s_cmp_eq_u32 s70, 0
    s_cbranch_scc1 L_nd
    s_sleep 10
L_nd:
    s_mov_b32 exec_lo, 0x33333333
    s_mov_b32 exec_hi, 0x33333333
    buffer_load_dwordx4 v[16:19], v136, s[24:27], s74 offen sc1
    buffer_load_dwordx4 v[20:23], v137, s[24:27], s74 offen sc1
    buffer_load_dwordx4 v[24:27], v138, s[24:27], s74 offen sc1
    buffer_load_dwordx4 v[28:31], v139, s[24:27], s74 offen sc1
    s_mov_b64 exec, -1
    s_waitcnt vmcnt(16) lgkmcnt(7)
    ds_read_b64_tr_b16 v[64:65], v8 offset:0
    ds_read_b64_tr_b16 v[66:67], v8 offset:512
    ds_read_b64_tr_b16 v[68:69], v9 offset:0
    ds_read_b64_tr_b16 v[70:71], v9 offset:512
    ds_read_b64_tr_b16 v[72:73], v10 offset:0
    ds_read_b64_tr_b16 v[74:75], v10 offset:512
    ds_read_b64_tr_b16 v[76:77], v11 offset:0
    ds_read_b64_tr_b16 v[78:79], v11 offset:512
    s_waitcnt vmcnt(12) lgkmcnt(7)
    ds_read_b64_tr_b16 v[80:81], v8 offset:4096
    ds_read_b64_tr_b16 v[82:83], v8 offset:4608
    ds_read_b64_tr_b16 v[84:85], v9 offset:4096
    ds_read_b64_tr_b16 v[86:87], v9 offset:4608
    ds_read_b64_tr_b16 v[88:89], v10 offset:4096
    ds_read_b64_tr_b16 v[90:91], v10 offset:4608
    ds_read_b64_tr_b16 v[92:93], v11 offset:4096
    ds_read_b64_tr_b16 v[94:95], v11 offset:4608
    s_waitcnt vmcnt(8) lgkmcnt(7)
    ds_read_b64_tr_b16 v[96:97], v8 offset:8192
    ds_read_b64_tr_b16 v[98:99], v8 offset:8704
    ds_read_b64_tr_b16 v[100:101], v9 offset:8192
    ds_read_b64_tr_b16 v[102:103], v9 offset:8704
    ds_read_b64_tr_b16 v[104:105], v10 offset:8192
    ds_read_b64_tr_b16 v[106:107], v10 offset:8704
    ds_read_b64_tr_b16 v[108:109], v11 offset:8192
    ds_read_b64_tr_b16 v[110:111], v11 offset:8704
    s_waitcnt vmcnt(4) lgkmcnt(7)
    ds_read_b64_tr_b16 v[112:113], v8 offset:12288
    ds_read_b64_tr_b16 v[114:115], v8 offset:12800
    ds_read_b64_tr_b16 v[116:117], v9 offset:12288
    ds_read_b64_tr_b16 v[118:119], v9 offset:12800
    ds_read_b64_tr_b16 v[120:121], v10 offset:12288
    ds_read_b64_tr_b16 v[122:123], v10 offset:12800
    ds_read_b64_tr_b16 v[124:125], v11 offset:12288
    ds_read_b64_tr_b16 v[126:127], v11 offset:12800
L_h1:
    s_waitcnt vmcnt(0)
    v_max3_u32 v34, v16, v17, v18
    v_max3_u32 v35, v19, v20, v21
    v_max3_u32 v36, v22, v23, v24
    v_max3_u32 v37, v25, v26, v27
    v_max3_u32 v34, v34, v28, v29
    v_max3_u32 v35, v35, v30, v31
    v_max3_u32 v34, v34, v35, v37
    v_max_u32 v34, v34, v36
    v_cmp_eq_u32 vcc, -1, v34
    s_cbranch_vccnz L_h1r
    s_mov_b64 exec, -1
    s_waitcnt lgkmcnt(8)
    v_mfma_f32_16x16x32_bf16 v[40:43], v[16:19], v[64:67], 0
    v_mfma_f32_16x16x32_bf16 v[44:47], v[16:19], v[68:71], 0
    v_mfma_f32_16x16x32_bf16 v[48:51], v[16:19], v[72:75], 0
    v_mfma_f32_16x16x32_bf16 v[52:55], v[16:19], v[76:79], 0
    v_mfma_f32_16x16x32_bf16 v[40:43], v[20:23], v[80:83], v[40:43]
    v_mfma_f32_16x16x32_bf16 v[44:47], v[20:23], v[84:87], v[44:47]
    v_mfma_f32_16x16x32_bf16 v[48:51], v[20:23], v[88:91], v[48:51]
    v_mfma_f32_16x16x32_bf16 v[52:55], v[20:23], v[92:95], v[52:55]
    v_mfma_f32_16x16x32_bf16 v[40:43], v[24:27], v[96:99], v[40:43]
    v_mfma_f32_16x16x32_bf16 v[44:47], v[24:27], v[100:103], v[44:47]
    v_mfma_f32_16x16x32_bf16 v[48:51], v[24:27], v[104:107], v[48:51]
    v_mfma_f32_16x16x32_bf16 v[52:55], v[24:27], v[108:111], v[52:55]
    s_waitcnt lgkmcnt(0)
    v_mfma_f32_16x16x32_bf16 v[40:43], v[28:31], v[112:115], v[40:43]
    v_mfma_f32_16x16x32_bf16 v[44:47], v[28:31], v[116:119], v[44:47]
    v_mfma_f32_16x16x32_bf16 v[48:51], v[28:31], v[120:123], v[48:51]
    v_mfma_f32_16x16x32_bf16 v[52:55], v[28:31], v[124:127], v[52:55]
    s_nop 5
    v_and_or_b32 v32, v40, s29, v128
    v_and_or_b32 v36, v41, s29, v128
    v_and_or_b32 v33, v44, s29, v129
    v_and_or_b32 v37, v45, s29, v129
    v_and_or_b32 v34, v48, s29, v130
    v_and_or_b32 v38, v49, s29, v130
    v_and_or_b32 v35, v52, s29, v131
    v_and_or_b32 v39, v53, s29, v131
    s_cmp_eq_u32 s75, 0
    s_cbranch_scc1 L_far_175
    buffer_store_dwordx4 v[32:35], v60, s[24:27], s76 offen
    buffer_store_dwordx4 v[36:39], v63, s[24:27], s76 offen
L_sent_176:
L_h2:
    buffer_load_dwordx4 v[16:19], v61, s[24:27], s76 offen sc1
    buffer_load_dwordx4 v[20:23], v14, s[24:27], s76 offen sc1
    s_waitcnt vmcnt(0)
    v_perm_b32 v24, v17, v16, s30
    v_perm_b32 v25, v19, v18, s31
    v_or_b32 v24, v24, v25
    v_xor_b32 v26, s28, v24
    v_perm_b32 v24, v21, v20, s30
    v_perm_b32 v25, v23, v22, s31
    v_or_b32 v24, v24, v25
    v_xor_b32 v24, s28, v24
    v_or_b32 v26, v26, v24
    v_cmp_ne_u32 vcc, 0, v26
    s_cbranch_vccz L_h2_ok
    s_mov_b64 exec, vcc
    s_sub_u32 s82, s82, 1
    s_cmp_lg_u32 s82, 0
    s_cbranch_scc1 L_h2
    s_endpgm
L_h2_ok:
    s_mov_b64 exec, -1
    v_and_b32 v16, s29, v16
    v_and_b32 v17, s29, v17
    v_and_b32 v18, s29, v18
    v_and_b32 v19, s29, v19
    v_and_b32 v20, s29, v20
    v_and_b32 v21, s29, v21
    v_and_b32 v22, s29, v22
    v_and_b32 v23, s29, v23
    v_add_f32 v16, v16, v20
    v_add_f32 v17, v17, v21
    v_add_f32 v18, v18, v22
    v_add_f32 v19, v19, v23
    s_nop 1
    v_permlane32_swap_b32 v16, v18
    v_permlane32_swap_b32 v17, v19
    s_nop 0
    v_add_f32 v16, v16, v18
    v_add_f32 v17, v17, v19
    s_nop 1
    v_permlane16_swap_b32 v16, v17
    s_nop 0
    v_add_f32 v16, v16, v17
    s_nop 1
    v_add_f32_dpp v17, v16, v16 row_ror:4 row_mask:0xf bank_mask:0xf
    s_nop 1
    v_add_f32_dpp v16, v17, v17 row_ror:8 row_mask:0xf bank_mask:0xf
    v_cvt_pk_bf16_f32 v16, v16, v16
    s_mov_b32 exec_lo, 0x000f000f
    s_mov_b32 exec_hi, 0x000f000f
    buffer_store_short v16, v62, s[12:15], s79 offen
    s_lshl1_add_u32 s4, s2, s70
    s_cmp_lg_u32 s4, 1
    s_cbranch_scc1 L_keep
    s_mov_b64 exec, 3
    v_lshlrev_b32 v20, 7, v0
    global_store_dword v20, v2, s[58:59]
L_keep:
L_hfin:
L_end:
    s_endpgm
L_rs_35:
    v_mov_b32 v61, v60
    s_nop 1
    v_permlane32_swap_b32 v61, v60
    s_nop 0
    v_max_f32 v60, v60, v61
    v_mov_b32 v61, v60
    s_nop 1
    v_permlane16_swap_b32 v61, v60
    s_nop 0
    v_max3_f32 v10, v10, v60, v61
    v_mul_f32 v60, s77, v10
    v_sub_f32 v61, v8, v60
    v_exp_f32 v61, v61
    v_mov_b32 v8, v60
    v_mul_f32 v9, v9, v61
    v_mul_f32 v32, v32, v61
    v_mul_f32 v33, v33, v61
    v_mul_f32 v34, v34, v61
    v_mul_f32 v35, v35, v61
    v_mul_f32 v36, v36, v61
    v_mul_f32 v37, v37, v61
    v_mul_f32 v38, v38, v61
    v_mul_f32 v39, v39, v61
    s_branch L_bk_36
L_rs_37:
    v_mov_b32 v61, v60
    s_nop 1
    v_permlane32_swap_b32 v61, v60
    s_nop 0
    v_max_f32 v60, v60, v61
    v_mov_b32 v61, v60
    s_nop 1
    v_permlane16_swap_b32 v61, v60
    s_nop 0
    v_max3_f32 v10, v10, v60, v61
    v_mul_f32 v60, s77, v10
    v_sub_f32 v61, v8, v60
    v_exp_f32 v61, v61
    v_mov_b32 v8, v60
    v_mul_f32 v9, v9, v61
    v_mul_f32 v32, v32, v61
    v_mul_f32 v33, v33, v61
    v_mul_f32 v34, v34, v61
    v_mul_f32 v35, v35, v61
    v_mul_f32 v36, v36, v61
    v_mul_f32 v37, v37, v61
    v_mul_f32 v38, v38, v61
    v_mul_f32 v39, v39, v61
    s_branch L_bk_38
L_rs_39:
    v_mov_b32 v61, v60
    s_nop 1
    v_permlane32_swap_b32 v61, v60
    s_nop 0
    v_max_f32 v60, v60, v61
    v_mov_b32 v61, v60
    s_nop 1
    v_permlane16_swap_b32 v61, v60
    s_nop 0
    v_max3_f32 v10, v10, v60, v61
    v_mul_f32 v60, s77, v10
    v_sub_f32 v61, v8, v60
    v_exp_f32 v61, v61
    v_mov_b32 v8, v60
    v_mul_f32 v9, v9, v61
    v_mul_f32 v32, v32, v61
    v_mul_f32 v33, v33, v61
    v_mul_f32 v34, v34, v61
    v_mul_f32 v35, v35, v61
    v_mul_f32 v36, v36, v61
    v_mul_f32 v37, v37, v61
    v_mul_f32 v38, v38, v61
    v_mul_f32 v39, v39, v61
    s_branch L_bk_40
L_rs_41:
    v_mov_b32 v61, v60
    s_nop 1
    v_permlane32_swap_b32 v61, v60
    s_nop 0
    v_max_f32 v60, v60, v61
    v_mov_b32 v61, v60
    s_nop 1
    v_permlane16_swap_b32 v61, v60
    s_nop 0
    v_max3_f32 v10, v10, v60, v61
    v_mul_f32 v60, s77, v10
    v_sub_f32 v61, v8, v60
    v_exp_f32 v61, v61
    v_mov_b32 v8, v60
    v_mul_f32 v9, v9, v61
    v_mul_f32 v32, v32, v61
    v_mul_f32 v33, v33, v61
    v_mul_f32 v34, v34, v61
    v_mul_f32 v35, v35, v61
    v_mul_f32 v36, v36, v61
    v_mul_f32 v37, v37, v61
    v_mul_f32 v38, v38, v61
    v_mul_f32 v39, v39, v61
    s_branch L_bk_42
L_far_113:
    buffer_store_dwordx4 v[128:131], v6, s[24:27], s72 offen sc1
    buffer_store_dwordx4 v[132:135], v7, s[24:27], s72 offen sc1
    s_branch L_sent_114
L_far_115:
    buffer_store_dwordx3 v[178:180], v8, s[24:27], s72 offen sc1
    s_branch L_sent_116
L_h1r:
    s_mov_b64 exec, vcc
    buffer_load_dwordx4 v[16:19], v136, s[24:27], s74 offen sc1
    buffer_load_dwordx4 v[20:23], v137, s[24:27], s74 offen sc1
    buffer_load_dwordx4 v[24:27], v138, s[24:27], s74 offen sc1
    buffer_load_dwordx4 v[28:31], v139, s[24:27], s74 offen sc1
    s_sub_u32 s82, s82, 1
    s_cmp_lg_u32 s82, 0
    s_cbranch_scc1 L_h1
    s_endpgm
L_far_175:
    buffer_store_dwordx4 v[32:35], v60, s[24:27], s76 offen sc1
    buffer_store_dwordx4 v[36:39], v63, s[24:27], s76 offen sc1
    s_branch L_sent_176
L_code_end:
.section .rodata,"a"
.p2align 6
.amdhsa_kernel concat_heads__sliding_block_cached__mha_block_cached__decode_kernel
  .amdhsa_next_free_vgpr 256
  .amdhsa_next_free_sgpr 102
  .amdhsa_accum_offset 256
  .amdhsa_group_segment_fixed_size 0
  .amdhsa_kernarg_size 104
  .amdhsa_user_sgpr_count 2
  .amdhsa_user_sgpr_kernarg_segment_ptr 1
  .amdhsa_system_sgpr_workgroup_id_x 1
.end_amdhsa_kernel
```
